```python
import torch

def _softmax(x, axis=-1):
    return torch.softmax(x, dim=axis)
def _gelu(x):
    return torch.nn.functional.gelu(x, approximate="tanh")
def _silu(x):
    return torch.nn.functional.silu(x)
def _sigmoid(x):
    return torch.sigmoid(x)
def _layernorm(x, axis=-1, eps=1e-5):
    m = x.mean(dim=axis, keepdim=True)
    v = x.var(dim=axis, keepdim=True, unbiased=False)
    return (x - m) / torch.sqrt(v + eps)
def _scatter_add(tgt, idx, src, axis=0):
    return tgt.clone().index_add_(axis, idx, src)
def _segment_sum(src, seg, n):
    out = torch.zeros((n,) + src.shape[1:], dtype=src.dtype)
    return out.index_add_(0, seg, src)
def _pad(x, pw):
    flat = tuple(v for pair in reversed(pw) for v in pair)
    return torch.nn.functional.pad(x, flat)

kernel_name = 'sequential_preLN__grouped_kv_mqa__dense_activation_relu__prompt'

def setup_inputs():

    _w = (lambda a: (lambda t: t.to(torch.bfloat16) if t.is_floating_point() else t)(torch.as_tensor(a)))
    def _A_setup():
        B, S, D, H = 1, 2048, 576, 32
        Dh = D // H
        return {
            "x": _w((lambda *s: torch.randn(*s, dtype=torch.bfloat16) * 0.05)(B, S, D)),
            "wq": _w((lambda *s: torch.randn(*s, dtype=torch.bfloat16) * 0.05)(D, H * Dh)),
            "wk": _w((lambda *s: torch.randn(*s, dtype=torch.bfloat16) * 0.05)(D, Dh)),
            "wv": _w((lambda *s: torch.randn(*s, dtype=torch.bfloat16) * 0.05)(D, Dh)),
            "wo": _w((lambda *s: torch.randn(*s, dtype=torch.bfloat16) * 0.05)(H * Dh, D)),
        }
    _A_in = _A_setup()

    def _B_setup():
        B, S, D, Dff = 1, 2048, 576, 4608
        return {
            "x": _w((lambda *s: torch.randn(*s, dtype=torch.bfloat16) * 0.05)(B, S, D)),
            "w1": _w((lambda *s: torch.randn(*s, dtype=torch.bfloat16) * 0.05)(D, Dff)),
            "w2": _w((lambda *s: torch.randn(*s, dtype=torch.bfloat16) * 0.05)(Dff, D)),
        }
    _B_in = _B_setup()

    return {
        "A_x": _A_in["x"],
        "A_wq": _A_in["wq"],
        "A_wk": _A_in["wk"],
        "A_wv": _A_in["wv"],
        "A_wo": _A_in["wo"],
        "B_x": _B_in["x"],
        "B_w1": _B_in["w1"],
        "B_w2": _B_in["w2"],
    }

def reference(A_x, A_wq, A_wk, A_wv, A_wo, B_x, B_w1, B_w2):
    def _A_ref(x, wq, wk, wv, wo):
        B, S, D = x.shape
        H = 32
        Dh = D // H
        q = (lambda x, *d: x.permute(*d))((x @ wq).reshape(B, S, H, Dh), 0, 2, 1, 3)
        k = x @ wk
        v = x @ wv
        scores = torch.einsum("bhqd,bkd->bhqk", q, k) * (Dh ** -0.5)
        p = _softmax(scores, axis=-1)
        o = torch.einsum("bhqk,bkd->bhqd", p, v)
        return (lambda x, *d: x.permute(*d))(o, 0, 2, 1, 3).reshape(B, S, H * Dh) @ wo

    def _B_ref(x, w1, w2):
        h = torch.einsum("bsd,df->bsf", x, w1)
        zero = torch.zeros_like(h)
        h = torch.maximum(h, zero)
        return torch.einsum("bsf,fd->bsd", h, w2)

    x = A_x
    h = x + _A_ref(_layernorm(x, axis=-1), A_wq, A_wk, A_wv, A_wo)
    h2 = h + _B_ref(_layernorm(h, axis=-1), B_w1, B_w2)
    return h2
```

```asm
; @launch grid=(256,1,1) block=(768,1,1) lds=163488
.amdgcn_target "amdgcn-amd-amdhsa--gfx950"
.text
.globl sequential_preLN__grouped_kv_mqa__dense_activation_relu__prompt_kernel
.p2align 8
.type sequential_preLN__grouped_kv_mqa__dense_activation_relu__prompt_kernel,@function
sequential_preLN__grouped_kv_mqa__dense_activation_relu__prompt_kernel:
    s_getpc_b64 s[62:63]
mega_pc:
    s_cmp_ge_u32 s2, 256
    s_cbranch_scc1 mega_end
    s_memrealtime s[60:61]
    s_load_dwordx2 s[10:11], s[0:1], 0
    s_load_dwordx4 s[68:71], s[0:1], 8
    s_load_dwordx2 s[72:73], s[0:1], 24
    s_load_dwordx2 s[8:9], s[0:1], 32
    s_load_dwordx4 s[4:7], s[0:1], 48
    s_load_dwordx2 s[14:15], s[0:1], 64
    s_load_dwordx2 s[74:75], s[0:1], 72
    s_load_dwordx2 s[12:13], s[0:1], 80
    v_and_b32 v1, 63, v0
    v_and_b32 v2, 15, v0
    v_bfe_u32 v3, v0, 4, 2
    v_lshrrev_b32 v7, 6, v0
    v_lshlrev_b32 v11, 4, v1
    v_readfirstlane_b32 s30, v7
    s_and_b32 s46, s2, 7
    s_lshr_b32 s47, s2, 3
    s_and_b32 s28, s47, 24
    s_add_u32 s28, s28, s46
    s_and_b32 s29, s47, 7
    s_lshr_b32 s48, s47, 3
    s_lshl_b32 s48, s48, 1
    s_add_u32 s48, s48, s29
    s_sub_u32 s34, s48, 9
    s_min_u32 s48, s48, s34
    s_lshl_b32 s48, s48, 1
    s_xor_b32 s34, s30, 7
    s_or_b32 s34, s34, s2
    s_waitcnt lgkmcnt(0)
    s_cbranch_scc1 a_s_nn
    s_or_b32 s60, s60, 1
    v_mov_b32 v14, s60
    v_mov_b32 v15, s61
    v_mov_b32 v10, 0
    s_mov_b32 exec_lo, 0x1
    s_mov_b32 exec_hi, 0x0
    global_store_dwordx2 v10, v[14:15], s[74:75] sc1
    s_mov_b64 exec, -1
a_s_nn:
    s_mov_b32 s16, s12
    s_mov_b32 s17, s13
    s_mov_b32 s18, 0x2bb0000
    s_mov_b32 s19, 0x00020000
    s_mov_b32 s20, s10
    s_mov_b32 s21, s11
    s_mov_b32 s22, 0x240000
    s_mov_b32 s23, 0x00020000
    s_mov_b32 s24, s8
    s_mov_b32 s25, s9
    s_mov_b32 s26, 0xa2000
    s_mov_b32 s27, 0x00020000
    s_cmp_ge_u32 s30, 8
    s_cbranch_scc1 mega_helper
    s_cmp_ge_u32 s30, 5
    s_cbranch_scc1 a_sw
    s_cmp_eq_u32 s30, 4
    s_cbranch_scc1 a_kvw
    s_setprio 2
    s_sub_u32 s34, s30, s29
    s_and_b32 s34, s34, 3
    s_mul_i32 s43, s34, 18432
    s_add_u32 s43, s43, 70656
    s_lshl_b32 s35, s28, 2
    s_add_u32 s35, s35, s30
    s_mul_i32 s35, s35, 18432
    s_lshl_b32 s36, s48, 6
    v_lshrrev_b32 v5, 2, v1
    v_sub_u32 v6, 4, v3
    v_xor_b32 v6, v6, v1
    v_and_b32 v6, 3, v6
    s_movk_i32 s41, 1152
    v_mul_u32_u24 v5, s41, v5
    v_lshl_add_u32 v4, v6, 4, v5
    v_add_u32 v4, s35, v4
    s_cmp_eq_u32 s34, 0
    s_cbranch_scc1 a_q_first
    s_barrier
a_q_first:
    s_add_u32 m0, s43, 0
    s_nop 0
    buffer_load_dwordx4 v4, s[20:23], s36 offen lds
    s_add_u32 s36, s36, 64
    s_cmp_eq_u32 s36, s41
    s_cselect_b32 s36, 0, s36
    s_add_u32 m0, s43, 1024
    s_nop 0
    buffer_load_dwordx4 v4, s[20:23], s36 offen lds
    s_add_u32 s36, s36, 64
    s_cmp_eq_u32 s36, s41
    s_cselect_b32 s36, 0, s36
    s_add_u32 m0, s43, 2048
    s_nop 0
    buffer_load_dwordx4 v4, s[20:23], s36 offen lds
    s_add_u32 s36, s36, 64
    s_cmp_eq_u32 s36, s41
    s_cselect_b32 s36, 0, s36
    s_add_u32 m0, s43, 3072
    s_nop 0
    buffer_load_dwordx4 v4, s[20:23], s36 offen lds
    s_add_u32 s36, s36, 64
    s_cmp_eq_u32 s36, s41
    s_cselect_b32 s36, 0, s36
    s_add_u32 m0, s43, 4096
    s_nop 0
    buffer_load_dwordx4 v4, s[20:23], s36 offen lds
    s_add_u32 s36, s36, 64
    s_cmp_eq_u32 s36, s41
    s_cselect_b32 s36, 0, s36
    s_add_u32 m0, s43, 5120
    s_nop 0
    buffer_load_dwordx4 v4, s[20:23], s36 offen lds
    s_add_u32 s36, s36, 64
    s_cmp_eq_u32 s36, s41
    s_cselect_b32 s36, 0, s36
    s_add_u32 m0, s43, 6144
    s_nop 0
    buffer_load_dwordx4 v4, s[20:23], s36 offen lds
    s_add_u32 s36, s36, 64
    s_cmp_eq_u32 s36, s41
    s_cselect_b32 s36, 0, s36
    s_add_u32 m0, s43, 7168
    s_nop 0
    buffer_load_dwordx4 v4, s[20:23], s36 offen lds
    s_add_u32 s36, s36, 64
    s_cmp_eq_u32 s36, s41
    s_cselect_b32 s36, 0, s36
    s_add_u32 m0, s43, 8192
    s_nop 0
    buffer_load_dwordx4 v4, s[20:23], s36 offen lds
    s_add_u32 s36, s36, 64
    s_cmp_eq_u32 s36, s41
    s_cselect_b32 s36, 0, s36
    s_add_u32 m0, s43, 9216
    s_nop 0
    buffer_load_dwordx4 v4, s[20:23], s36 offen lds
    s_add_u32 s36, s36, 64
    s_cmp_eq_u32 s36, s41
    s_cselect_b32 s36, 0, s36
    s_add_u32 m0, s43, 10240
    s_nop 0
    buffer_load_dwordx4 v4, s[20:23], s36 offen lds
    s_add_u32 s36, s36, 64
    s_cmp_eq_u32 s36, s41
    s_cselect_b32 s36, 0, s36
    s_add_u32 m0, s43, 11264
    s_nop 0
    buffer_load_dwordx4 v4, s[20:23], s36 offen lds
    s_add_u32 s36, s36, 64
    s_cmp_eq_u32 s36, s41
    s_cselect_b32 s36, 0, s36
    s_add_u32 m0, s43, 12288
    s_nop 0
    buffer_load_dwordx4 v4, s[20:23], s36 offen lds
    s_add_u32 s36, s36, 64
    s_cmp_eq_u32 s36, s41
    s_cselect_b32 s36, 0, s36
    s_add_u32 m0, s43, 13312
    s_nop 0
    buffer_load_dwordx4 v4, s[20:23], s36 offen lds
    s_add_u32 s36, s36, 64
    s_cmp_eq_u32 s36, s41
    s_cselect_b32 s36, 0, s36
    s_add_u32 m0, s43, 14336
    s_nop 0
    buffer_load_dwordx4 v4, s[20:23], s36 offen lds
    s_add_u32 s36, s36, 64
    s_cmp_eq_u32 s36, s41
    s_cselect_b32 s36, 0, s36
    s_add_u32 m0, s43, 15360
    s_nop 0
    buffer_load_dwordx4 v4, s[20:23], s36 offen lds
    s_add_u32 s36, s36, 64
    s_cmp_eq_u32 s36, s41
    s_cselect_b32 s36, 0, s36
    s_add_u32 m0, s43, 16384
    s_nop 0
    buffer_load_dwordx4 v4, s[20:23], s36 offen lds
    s_add_u32 s36, s36, 64
    s_cmp_eq_u32 s36, s41
    s_cselect_b32 s36, 0, s36
    s_add_u32 m0, s43, 17408
    s_nop 0
    buffer_load_dwordx4 v4, s[20:23], s36 offen lds
    s_add_u32 s36, s36, 64
    s_cmp_eq_u32 s36, s41
    s_cselect_b32 s36, 0, s36
    s_cmp_lg_u32 s34, 0
    s_cbranch_scc1 a_q_second
    s_barrier
a_q_second:
    v_lshrrev_b32 v32, 2, v2
    v_and_b32 v33, 1, v3
    v_lshlrev_b32 v33, 2, v33
    v_add_u32 v32, v32, v33
    v_lshl_add_u32 v32, v3, 3, v32
    v_xor_b32 v33, 4, v32
    s_movk_i32 s40, 160
    v_and_b32 v34, 3, v2
    v_lshlrev_b32 v34, 3, v34
    v_add_u32 v34, 29696, v34
    v_mad_u32_u24 v28, v32, s40, v34
    v_mad_u32_u24 v29, v33, s40, v34
    v_add_u32 v30, 59392, v28
    v_add_u32 v31, 59392, v29
    v_lshrrev_b32 v35, 2, v2
    v_sub_u32 v35, 4, v35
    v_and_b32 v35, 3, v35
    v_xor_b32 v35, v35, v3
    v_lshlrev_b32 v35, 4, v35
    v_lshl_add_u32 v35, v2, 6, v35
    v_add_u32 v35, s43, v35
    v_mov_b32 v120, 0
    v_mov_b32 v121, 0
    v_mov_b32 v122, 0
    v_mov_b32 v123, 0
    v_mov_b32 v124, 0
    v_mov_b32 v125, 0
    v_mov_b32 v126, 0
    v_mov_b32 v127, 0
    v_mov_b32 v128, 0
    v_mov_b32 v129, 0
    v_mov_b32 v130, 0
    v_mov_b32 v131, 0
    v_mov_b32 v132, 0
    v_mov_b32 v133, 0
    v_mov_b32 v134, 0
    v_mov_b32 v135, 0
    v_mov_b32 v136, 0
    v_mov_b32 v137, 0
    v_mov_b32 v138, 0
    v_mov_b32 v139, 0
    v_mov_b32 v16, 0
    v_mov_b32 v17, 0
    v_mov_b32 v18, 0
    v_mov_b32 v19, 0
    v_mov_b32 v20, 0
    v_mov_b32 v21, 0
    v_mov_b32 v22, 0
    v_mov_b32 v23, 0
    v_mov_b32 v24, 0
    v_mov_b32 v25, 0
    v_mov_b32 v26, 0
    v_mov_b32 v27, 0
    v_mov_b32 v40, 0
    v_mov_b32 v41, 0
    v_mov_b32 v42, 0
    v_mov_b32 v43, 0
    v_mov_b32 v44, 0
    v_mov_b32 v45, 0
    v_mov_b32 v46, 0
    v_mov_b32 v47, 0
    v_mov_b32 v36, 0x3f803f80
    v_mov_b32 v37, 0x3f803f80
    v_mov_b32 v38, 0x3f803f80
    v_mov_b32 v39, 0x3f803f80
    v_mov_b32 v6, 0
    v_mov_b32 v7, 0
    s_waitcnt vmcnt(12)
    ds_read_b128 v[48:51], v35 offset:0
    ds_read_b128 v[52:55], v35 offset:1024
    ds_read_b128 v[56:59], v35 offset:2048
    ds_read_b128 v[60:63], v35 offset:3072
    ds_read_b128 v[64:67], v35 offset:4096
    ds_read_b128 v[68:71], v35 offset:5120
    s_waitcnt vmcnt(6)
    ds_read_b128 v[72:75], v35 offset:6144
    ds_read_b128 v[76:79], v35 offset:7168
    ds_read_b128 v[80:83], v35 offset:8192
    ds_read_b128 v[84:87], v35 offset:9216
    ds_read_b128 v[88:91], v35 offset:10240
    ds_read_b128 v[92:95], v35 offset:11264
    s_waitcnt lgkmcnt(6)
    v_dot2c_f32_bf16 v6, v48, v36
    v_dot2c_f32_bf16 v7, v48, v48
    v_dot2c_f32_bf16 v6, v49, v36
    v_dot2c_f32_bf16 v7, v49, v49
    v_dot2c_f32_bf16 v6, v50, v36
    v_dot2c_f32_bf16 v7, v50, v50
    v_dot2c_f32_bf16 v6, v51, v36
    v_dot2c_f32_bf16 v7, v51, v51
    v_dot2c_f32_bf16 v6, v52, v36
    v_dot2c_f32_bf16 v7, v52, v52
    v_dot2c_f32_bf16 v6, v53, v36
    v_dot2c_f32_bf16 v7, v53, v53
    v_dot2c_f32_bf16 v6, v54, v36
    v_dot2c_f32_bf16 v7, v54, v54
    v_dot2c_f32_bf16 v6, v55, v36
    v_dot2c_f32_bf16 v7, v55, v55
    v_dot2c_f32_bf16 v6, v56, v36
    v_dot2c_f32_bf16 v7, v56, v56
    v_dot2c_f32_bf16 v6, v57, v36
    v_dot2c_f32_bf16 v7, v57, v57
    v_dot2c_f32_bf16 v6, v58, v36
    v_dot2c_f32_bf16 v7, v58, v58
    v_dot2c_f32_bf16 v6, v59, v36
    v_dot2c_f32_bf16 v7, v59, v59
    v_dot2c_f32_bf16 v6, v60, v36
    v_dot2c_f32_bf16 v7, v60, v60
    v_dot2c_f32_bf16 v6, v61, v36
    v_dot2c_f32_bf16 v7, v61, v61
    v_dot2c_f32_bf16 v6, v62, v36
    v_dot2c_f32_bf16 v7, v62, v62
    v_dot2c_f32_bf16 v6, v63, v36
    v_dot2c_f32_bf16 v7, v63, v63
    v_dot2c_f32_bf16 v6, v64, v36
    v_dot2c_f32_bf16 v7, v64, v64
    v_dot2c_f32_bf16 v6, v65, v36
    v_dot2c_f32_bf16 v7, v65, v65
    v_dot2c_f32_bf16 v6, v66, v36
    v_dot2c_f32_bf16 v7, v66, v66
    v_dot2c_f32_bf16 v6, v67, v36
    v_dot2c_f32_bf16 v7, v67, v67
    v_dot2c_f32_bf16 v6, v68, v36
    v_dot2c_f32_bf16 v7, v68, v68
    v_dot2c_f32_bf16 v6, v69, v36
    v_dot2c_f32_bf16 v7, v69, v69
    v_dot2c_f32_bf16 v6, v70, v36
    v_dot2c_f32_bf16 v7, v70, v70
    v_dot2c_f32_bf16 v6, v71, v36
    v_dot2c_f32_bf16 v7, v71, v71
    s_waitcnt vmcnt(0)
    s_cmp_lg_u32 s34, 0
    s_cbranch_scc1 a_q_nosig
    v_mov_b32 v12, 163416
    v_mov_b32 v13, 1
    s_mov_b32 exec_lo, 0x1
    s_mov_b32 exec_hi, 0x0
    ds_add_u32 v12, v13
    s_mov_b64 exec, -1
a_q_nosig:
    ds_read_b128 v[96:99], v35 offset:12288
    ds_read_b128 v[100:103], v35 offset:13312
    ds_read_b128 v[104:107], v35 offset:14336
    ds_read_b128 v[108:111], v35 offset:15360
    ds_read_b128 v[112:115], v35 offset:16384
    ds_read_b128 v[116:119], v35 offset:17408
    s_waitcnt lgkmcnt(6)
    v_dot2c_f32_bf16 v6, v72, v36
    v_dot2c_f32_bf16 v7, v72, v72
    v_dot2c_f32_bf16 v6, v73, v36
    v_dot2c_f32_bf16 v7, v73, v73
    v_dot2c_f32_bf16 v6, v74, v36
    v_dot2c_f32_bf16 v7, v74, v74
    v_dot2c_f32_bf16 v6, v75, v36
    v_dot2c_f32_bf16 v7, v75, v75
    v_dot2c_f32_bf16 v6, v76, v36
    v_dot2c_f32_bf16 v7, v76, v76
    v_dot2c_f32_bf16 v6, v77, v36
    v_dot2c_f32_bf16 v7, v77, v77
    v_dot2c_f32_bf16 v6, v78, v36
    v_dot2c_f32_bf16 v7, v78, v78
    v_dot2c_f32_bf16 v6, v79, v36
    v_dot2c_f32_bf16 v7, v79, v79
    v_dot2c_f32_bf16 v6, v80, v36
    v_dot2c_f32_bf16 v7, v80, v80
    v_dot2c_f32_bf16 v6, v81, v36
    v_dot2c_f32_bf16 v7, v81, v81
    v_dot2c_f32_bf16 v6, v82, v36
    v_dot2c_f32_bf16 v7, v82, v82
    v_dot2c_f32_bf16 v6, v83, v36
    v_dot2c_f32_bf16 v7, v83, v83
    v_dot2c_f32_bf16 v6, v84, v36
    v_dot2c_f32_bf16 v7, v84, v84
    v_dot2c_f32_bf16 v6, v85, v36
    v_dot2c_f32_bf16 v7, v85, v85
    v_dot2c_f32_bf16 v6, v86, v36
    v_dot2c_f32_bf16 v7, v86, v86
    v_dot2c_f32_bf16 v6, v87, v36
    v_dot2c_f32_bf16 v7, v87, v87
    v_dot2c_f32_bf16 v6, v88, v36
    v_dot2c_f32_bf16 v7, v88, v88
    v_dot2c_f32_bf16 v6, v89, v36
    v_dot2c_f32_bf16 v7, v89, v89
    v_dot2c_f32_bf16 v6, v90, v36
    v_dot2c_f32_bf16 v7, v90, v90
    v_dot2c_f32_bf16 v6, v91, v36
    v_dot2c_f32_bf16 v7, v91, v91
    v_dot2c_f32_bf16 v6, v92, v36
    v_dot2c_f32_bf16 v7, v92, v92
    v_dot2c_f32_bf16 v6, v93, v36
    v_dot2c_f32_bf16 v7, v93, v93
    v_dot2c_f32_bf16 v6, v94, v36
    v_dot2c_f32_bf16 v7, v94, v94
    v_dot2c_f32_bf16 v6, v95, v36
    v_dot2c_f32_bf16 v7, v95, v95
    s_waitcnt lgkmcnt(0)
    v_mov_b32 v12, 163420
    v_mov_b32 v13, 1
    s_mov_b32 exec_lo, 0x1
    s_mov_b32 exec_hi, 0x0
    ds_add_u32 v12, v13
    s_mov_b64 exec, -1
    v_dot2c_f32_bf16 v6, v96, v36
    v_dot2c_f32_bf16 v7, v96, v96
    v_dot2c_f32_bf16 v6, v97, v36
    v_dot2c_f32_bf16 v7, v97, v97
    v_dot2c_f32_bf16 v6, v98, v36
    v_dot2c_f32_bf16 v7, v98, v98
    v_dot2c_f32_bf16 v6, v99, v36
    v_dot2c_f32_bf16 v7, v99, v99
    v_dot2c_f32_bf16 v6, v100, v36
    v_dot2c_f32_bf16 v7, v100, v100
    v_dot2c_f32_bf16 v6, v101, v36
    v_dot2c_f32_bf16 v7, v101, v101
    v_dot2c_f32_bf16 v6, v102, v36
    v_dot2c_f32_bf16 v7, v102, v102
    v_dot2c_f32_bf16 v6, v103, v36
    v_dot2c_f32_bf16 v7, v103, v103
    v_dot2c_f32_bf16 v6, v104, v36
    v_dot2c_f32_bf16 v7, v104, v104
    v_dot2c_f32_bf16 v6, v105, v36
    v_dot2c_f32_bf16 v7, v105, v105
    v_dot2c_f32_bf16 v6, v106, v36
    v_dot2c_f32_bf16 v7, v106, v106
    v_dot2c_f32_bf16 v6, v107, v36
    v_dot2c_f32_bf16 v7, v107, v107
    v_dot2c_f32_bf16 v6, v108, v36
    v_dot2c_f32_bf16 v7, v108, v108
    v_dot2c_f32_bf16 v6, v109, v36
    v_dot2c_f32_bf16 v7, v109, v109
    v_dot2c_f32_bf16 v6, v110, v36
    v_dot2c_f32_bf16 v7, v110, v110
    v_dot2c_f32_bf16 v6, v111, v36
    v_dot2c_f32_bf16 v7, v111, v111
    v_dot2c_f32_bf16 v6, v112, v36
    v_dot2c_f32_bf16 v7, v112, v112
    v_dot2c_f32_bf16 v6, v113, v36
    v_dot2c_f32_bf16 v7, v113, v113
    v_dot2c_f32_bf16 v6, v114, v36
    v_dot2c_f32_bf16 v7, v114, v114
    v_dot2c_f32_bf16 v6, v115, v36
    v_dot2c_f32_bf16 v7, v115, v115
    v_dot2c_f32_bf16 v6, v116, v36
    v_dot2c_f32_bf16 v7, v116, v116
    v_dot2c_f32_bf16 v6, v117, v36
    v_dot2c_f32_bf16 v7, v117, v117
    v_dot2c_f32_bf16 v6, v118, v36
    v_dot2c_f32_bf16 v7, v118, v118
    v_dot2c_f32_bf16 v6, v119, v36
    v_dot2c_f32_bf16 v7, v119, v119
    s_nop 1
    v_mov_b32 v32, v6
    v_mov_b32 v33, v7
    s_nop 0
    v_permlane16_swap_b32 v6, v32
    v_permlane16_swap_b32 v7, v33
    v_add_f32 v6, v6, v32
    v_add_f32 v7, v7, v33
    v_mov_b32 v32, v6
    v_mov_b32 v33, v7
    s_nop 0
    v_permlane32_swap_b32 v6, v32
    v_permlane32_swap_b32 v7, v33
    v_add_f32 v6, v6, v32
    v_add_f32 v7, v7, v33
    v_mul_f32 v6, 0x3ae38e39, v6
    v_mul_f32 v7, 0x3ae38e39, v7
    v_fma_f32 v7, -v6, v6, v7
    v_max_f32 v7, 0, v7
    v_add_f32 v7, 0x3727c5ac, v7
    v_rsq_f32 v7, v7
    s_cmp_lg_u32 s34, 0
    s_cbranch_scc1 a_q_nost
    v_lshlrev_b32 v32, 2, v2
    v_add_u32 v32, 161472, v32
    ds_write_b32 v32, v6
    ds_write_b32 v32, v7 offset:64
    s_waitcnt lgkmcnt(0)
    v_mov_b32 v12, 163404
    v_mov_b32 v13, 1
    s_mov_b32 exec_lo, 0x1
    s_mov_b32 exec_hi, 0x0
    ds_add_u32 v12, v13
    s_mov_b64 exec, -1
a_q_nost:
    v_mul_f32 v34, 0x3eae1a93, v7
    s_mul_i32 s35, s30, 2304
    s_add_u32 s35, s35, 151808
    v_lshrrev_b32 v35, 1, v3
    v_lshlrev_b32 v35, 8, v35
    v_lshl_add_u32 v35, v2, 4, v35
    v_and_b32 v32, 1, v3
    v_lshl_add_u32 v35, v32, 3, v35
    v_add_u32 v35, s35, v35
a_q_gemm:
    s_cmp_ge_u32 s30, 4
    s_cbranch_scc1 mega_lwd_q0
    v_mov_b32 v12, 163392
    s_mov_b32 s3, 524288
mega_lw_q0:
    ds_read_b32 v13, v12
    s_waitcnt lgkmcnt(0)
    v_readfirstlane_b32 s39, v13
    s_nop 0
    s_cmp_ge_u32 s39, 4
    s_cbranch_scc1 mega_lwd_q0
    s_sleep 1
    s_sub_u32 s3, s3, 1
    s_cbranch_scc0 mega_lw_q0
mega_lwd_q0:
    ds_read_b64_tr_b16 v[140:141], v28 offset:0
    ds_read_b64_tr_b16 v[142:143], v29 offset:0
    ds_read_b64_tr_b16 v[144:145], v28 offset:32
    ds_read_b64_tr_b16 v[146:147], v29 offset:32
    ds_read_b64_tr_b16 v[148:149], v28 offset:64
    ds_read_b64_tr_b16 v[150:151], v29 offset:64
    ds_read_b64_tr_b16 v[152:153], v28 offset:96
    ds_read_b64_tr_b16 v[154:155], v29 offset:96
    ds_read_b64_tr_b16 v[156:157], v28 offset:128
    ds_read_b64_tr_b16 v[158:159], v29 offset:128
    ds_read_b64_tr_b16 v[160:161], v28 offset:5120
    ds_read_b64_tr_b16 v[162:163], v29 offset:5120
    ds_read_b64_tr_b16 v[164:165], v28 offset:5152
    ds_read_b64_tr_b16 v[166:167], v29 offset:5152
    s_waitcnt lgkmcnt(12)
    v_mfma_f32_16x16x32_bf16 v[120:123], v[140:143], v[48:51], v[120:123]
    v_mfma_f32_16x16x32_bf16 v[16:19], v[140:143], v[36:39], v[16:19]
    s_waitcnt lgkmcnt(10)
    v_mfma_f32_16x16x32_bf16 v[124:127], v[144:147], v[48:51], v[124:127]
    ds_read_b64_tr_b16 v[140:141], v28 offset:5184
    v_mfma_f32_16x16x32_bf16 v[20:23], v[144:147], v[36:39], v[20:23]
    ds_read_b64_tr_b16 v[142:143], v29 offset:5184
    s_waitcnt lgkmcnt(10)
    v_mfma_f32_16x16x32_bf16 v[128:131], v[148:151], v[48:51], v[128:131]
    ds_read_b64_tr_b16 v[144:145], v28 offset:5216
    v_mfma_f32_16x16x32_bf16 v[24:27], v[148:151], v[36:39], v[24:27]
    ds_read_b64_tr_b16 v[146:147], v29 offset:5216
    s_waitcnt lgkmcnt(10)
    v_mfma_f32_16x16x32_bf16 v[132:135], v[152:155], v[48:51], v[132:135]
    ds_read_b64_tr_b16 v[148:149], v28 offset:5248
    v_mfma_f32_16x16x32_bf16 v[40:43], v[152:155], v[36:39], v[40:43]
    ds_read_b64_tr_b16 v[150:151], v29 offset:5248
    s_waitcnt lgkmcnt(10)
    v_mfma_f32_16x16x32_bf16 v[136:139], v[156:159], v[48:51], v[136:139]
    ds_read_b64_tr_b16 v[152:153], v28 offset:10240
    v_mfma_f32_16x16x32_bf16 v[44:47], v[156:159], v[36:39], v[44:47]
    ds_read_b64_tr_b16 v[154:155], v29 offset:10240
    s_waitcnt lgkmcnt(10)
    v_mfma_f32_16x16x32_bf16 v[120:123], v[160:163], v[52:55], v[120:123]
    ds_read_b64_tr_b16 v[156:157], v28 offset:10272
    v_mfma_f32_16x16x32_bf16 v[16:19], v[160:163], v[36:39], v[16:19]
    ds_read_b64_tr_b16 v[158:159], v29 offset:10272
    s_waitcnt lgkmcnt(10)
    v_mfma_f32_16x16x32_bf16 v[124:127], v[164:167], v[52:55], v[124:127]
    ds_read_b64_tr_b16 v[160:161], v28 offset:10304
    v_mfma_f32_16x16x32_bf16 v[20:23], v[164:167], v[36:39], v[20:23]
    ds_read_b64_tr_b16 v[162:163], v29 offset:10304
    s_waitcnt lgkmcnt(10)
    v_mfma_f32_16x16x32_bf16 v[128:131], v[140:143], v[52:55], v[128:131]
    ds_read_b64_tr_b16 v[164:165], v28 offset:10336
    v_mfma_f32_16x16x32_bf16 v[24:27], v[140:143], v[36:39], v[24:27]
    ds_read_b64_tr_b16 v[166:167], v29 offset:10336
    s_waitcnt lgkmcnt(10)
    v_mfma_f32_16x16x32_bf16 v[132:135], v[144:147], v[52:55], v[132:135]
    ds_read_b64_tr_b16 v[140:141], v28 offset:10368
    v_mfma_f32_16x16x32_bf16 v[40:43], v[144:147], v[36:39], v[40:43]
    ds_read_b64_tr_b16 v[142:143], v29 offset:10368
    s_waitcnt lgkmcnt(10)
    v_mfma_f32_16x16x32_bf16 v[136:139], v[148:151], v[52:55], v[136:139]
    ds_read_b64_tr_b16 v[144:145], v28 offset:15360
    v_mfma_f32_16x16x32_bf16 v[44:47], v[148:151], v[36:39], v[44:47]
    ds_read_b64_tr_b16 v[146:147], v29 offset:15360
    s_waitcnt lgkmcnt(10)
    v_mfma_f32_16x16x32_bf16 v[120:123], v[152:155], v[56:59], v[120:123]
    ds_read_b64_tr_b16 v[148:149], v28 offset:15392
    v_mfma_f32_16x16x32_bf16 v[16:19], v[152:155], v[36:39], v[16:19]
    ds_read_b64_tr_b16 v[150:151], v29 offset:15392
    s_waitcnt lgkmcnt(10)
    v_mfma_f32_16x16x32_bf16 v[124:127], v[156:159], v[56:59], v[124:127]
    ds_read_b64_tr_b16 v[152:153], v28 offset:15424
    v_mfma_f32_16x16x32_bf16 v[20:23], v[156:159], v[36:39], v[20:23]
    ds_read_b64_tr_b16 v[154:155], v29 offset:15424
    s_waitcnt lgkmcnt(10)
    v_mfma_f32_16x16x32_bf16 v[128:131], v[160:163], v[56:59], v[128:131]
    ds_read_b64_tr_b16 v[156:157], v28 offset:15456
    v_mfma_f32_16x16x32_bf16 v[24:27], v[160:163], v[36:39], v[24:27]
    ds_read_b64_tr_b16 v[158:159], v29 offset:15456
    s_waitcnt lgkmcnt(10)
    v_mfma_f32_16x16x32_bf16 v[132:135], v[164:167], v[56:59], v[132:135]
    ds_read_b64_tr_b16 v[160:161], v28 offset:15488
    v_mfma_f32_16x16x32_bf16 v[40:43], v[164:167], v[36:39], v[40:43]
    ds_read_b64_tr_b16 v[162:163], v29 offset:15488
    s_waitcnt lgkmcnt(10)
    v_mfma_f32_16x16x32_bf16 v[136:139], v[140:143], v[56:59], v[136:139]
    ds_read_b64_tr_b16 v[164:165], v28 offset:20480
    v_mfma_f32_16x16x32_bf16 v[44:47], v[140:143], v[36:39], v[44:47]
    ds_read_b64_tr_b16 v[166:167], v29 offset:20480
    s_waitcnt lgkmcnt(10)
    v_mfma_f32_16x16x32_bf16 v[120:123], v[144:147], v[60:63], v[120:123]
    ds_read_b64_tr_b16 v[140:141], v28 offset:20512
    v_mfma_f32_16x16x32_bf16 v[16:19], v[144:147], v[36:39], v[16:19]
    ds_read_b64_tr_b16 v[142:143], v29 offset:20512
    s_waitcnt lgkmcnt(10)
    v_mfma_f32_16x16x32_bf16 v[124:127], v[148:151], v[60:63], v[124:127]
    ds_read_b64_tr_b16 v[144:145], v28 offset:20544
    v_mfma_f32_16x16x32_bf16 v[20:23], v[148:151], v[36:39], v[20:23]
    ds_read_b64_tr_b16 v[146:147], v29 offset:20544
    s_waitcnt lgkmcnt(10)
    v_mfma_f32_16x16x32_bf16 v[128:131], v[152:155], v[60:63], v[128:131]
    ds_read_b64_tr_b16 v[148:149], v28 offset:20576
    v_mfma_f32_16x16x32_bf16 v[24:27], v[152:155], v[36:39], v[24:27]
    ds_read_b64_tr_b16 v[150:151], v29 offset:20576
    s_waitcnt lgkmcnt(10)
    v_mfma_f32_16x16x32_bf16 v[132:135], v[156:159], v[60:63], v[132:135]
    ds_read_b64_tr_b16 v[152:153], v28 offset:20608
    v_mfma_f32_16x16x32_bf16 v[40:43], v[156:159], v[36:39], v[40:43]
    ds_read_b64_tr_b16 v[154:155], v29 offset:20608
    s_waitcnt lgkmcnt(10)
    v_mfma_f32_16x16x32_bf16 v[136:139], v[160:163], v[60:63], v[136:139]
    ds_read_b64_tr_b16 v[156:157], v28 offset:25600
    v_mfma_f32_16x16x32_bf16 v[44:47], v[160:163], v[36:39], v[44:47]
    ds_read_b64_tr_b16 v[158:159], v29 offset:25600
    s_waitcnt lgkmcnt(10)
    v_mfma_f32_16x16x32_bf16 v[120:123], v[164:167], v[64:67], v[120:123]
    ds_read_b64_tr_b16 v[160:161], v28 offset:25632
    v_mfma_f32_16x16x32_bf16 v[16:19], v[164:167], v[36:39], v[16:19]
    ds_read_b64_tr_b16 v[162:163], v29 offset:25632
    s_waitcnt lgkmcnt(10)
    v_mfma_f32_16x16x32_bf16 v[124:127], v[140:143], v[64:67], v[124:127]
    ds_read_b64_tr_b16 v[164:165], v28 offset:25664
    v_mfma_f32_16x16x32_bf16 v[20:23], v[140:143], v[36:39], v[20:23]
    ds_read_b64_tr_b16 v[166:167], v29 offset:25664
    s_waitcnt lgkmcnt(10)
    v_mfma_f32_16x16x32_bf16 v[128:131], v[144:147], v[64:67], v[128:131]
    ds_read_b64_tr_b16 v[140:141], v28 offset:25696
    v_mfma_f32_16x16x32_bf16 v[24:27], v[144:147], v[36:39], v[24:27]
    ds_read_b64_tr_b16 v[142:143], v29 offset:25696
    s_waitcnt lgkmcnt(10)
    v_mfma_f32_16x16x32_bf16 v[132:135], v[148:151], v[64:67], v[132:135]
    ds_read_b64_tr_b16 v[144:145], v28 offset:25728
    v_mfma_f32_16x16x32_bf16 v[40:43], v[148:151], v[36:39], v[40:43]
    ds_read_b64_tr_b16 v[146:147], v29 offset:25728
    s_waitcnt lgkmcnt(10)
    v_mfma_f32_16x16x32_bf16 v[136:139], v[152:155], v[64:67], v[136:139]
    ds_read_b64_tr_b16 v[148:149], v28 offset:30720
    v_mfma_f32_16x16x32_bf16 v[44:47], v[152:155], v[36:39], v[44:47]
    ds_read_b64_tr_b16 v[150:151], v29 offset:30720
    s_waitcnt lgkmcnt(10)
    v_mfma_f32_16x16x32_bf16 v[120:123], v[156:159], v[68:71], v[120:123]
    ds_read_b64_tr_b16 v[152:153], v28 offset:30752
    v_mfma_f32_16x16x32_bf16 v[16:19], v[156:159], v[36:39], v[16:19]
    ds_read_b64_tr_b16 v[154:155], v29 offset:30752
    s_waitcnt lgkmcnt(10)
    v_mfma_f32_16x16x32_bf16 v[124:127], v[160:163], v[68:71], v[124:127]
    ds_read_b64_tr_b16 v[156:157], v28 offset:30784
    v_mfma_f32_16x16x32_bf16 v[20:23], v[160:163], v[36:39], v[20:23]
    ds_read_b64_tr_b16 v[158:159], v29 offset:30784
    s_waitcnt lgkmcnt(10)
    v_mfma_f32_16x16x32_bf16 v[128:131], v[164:167], v[68:71], v[128:131]
    ds_read_b64_tr_b16 v[160:161], v28 offset:30816
    v_mfma_f32_16x16x32_bf16 v[24:27], v[164:167], v[36:39], v[24:27]
    ds_read_b64_tr_b16 v[162:163], v29 offset:30816
    s_waitcnt lgkmcnt(10)
    v_mfma_f32_16x16x32_bf16 v[132:135], v[140:143], v[68:71], v[132:135]
    ds_read_b64_tr_b16 v[164:165], v28 offset:30848
    v_mfma_f32_16x16x32_bf16 v[40:43], v[140:143], v[36:39], v[40:43]
    ds_read_b64_tr_b16 v[166:167], v29 offset:30848
    s_waitcnt lgkmcnt(10)
    v_mfma_f32_16x16x32_bf16 v[136:139], v[144:147], v[68:71], v[136:139]
    ds_read_b64_tr_b16 v[140:141], v28 offset:35840
    v_mfma_f32_16x16x32_bf16 v[44:47], v[144:147], v[36:39], v[44:47]
    ds_read_b64_tr_b16 v[142:143], v29 offset:35840
    s_waitcnt lgkmcnt(10)
    v_mfma_f32_16x16x32_bf16 v[120:123], v[148:151], v[72:75], v[120:123]
    ds_read_b64_tr_b16 v[144:145], v28 offset:35872
    v_mfma_f32_16x16x32_bf16 v[16:19], v[148:151], v[36:39], v[16:19]
    ds_read_b64_tr_b16 v[146:147], v29 offset:35872
    s_waitcnt lgkmcnt(10)
    v_mfma_f32_16x16x32_bf16 v[124:127], v[152:155], v[72:75], v[124:127]
    ds_read_b64_tr_b16 v[148:149], v28 offset:35904
    v_mfma_f32_16x16x32_bf16 v[20:23], v[152:155], v[36:39], v[20:23]
    ds_read_b64_tr_b16 v[150:151], v29 offset:35904
    s_waitcnt lgkmcnt(10)
    v_mfma_f32_16x16x32_bf16 v[128:131], v[156:159], v[72:75], v[128:131]
    ds_read_b64_tr_b16 v[152:153], v28 offset:35936
    v_mfma_f32_16x16x32_bf16 v[24:27], v[156:159], v[36:39], v[24:27]
    ds_read_b64_tr_b16 v[154:155], v29 offset:35936
    s_waitcnt lgkmcnt(10)
    v_mfma_f32_16x16x32_bf16 v[132:135], v[160:163], v[72:75], v[132:135]
    ds_read_b64_tr_b16 v[156:157], v28 offset:35968
    v_mfma_f32_16x16x32_bf16 v[40:43], v[160:163], v[36:39], v[40:43]
    ds_read_b64_tr_b16 v[158:159], v29 offset:35968
    s_waitcnt lgkmcnt(10)
    v_mfma_f32_16x16x32_bf16 v[136:139], v[164:167], v[72:75], v[136:139]
    v_mfma_f32_16x16x32_bf16 v[44:47], v[164:167], v[36:39], v[44:47]
    s_waitcnt lgkmcnt(8)
    v_mfma_f32_16x16x32_bf16 v[120:123], v[140:143], v[76:79], v[120:123]
    v_mfma_f32_16x16x32_bf16 v[16:19], v[140:143], v[36:39], v[16:19]
    s_waitcnt lgkmcnt(6)
    v_mfma_f32_16x16x32_bf16 v[124:127], v[144:147], v[76:79], v[124:127]
    v_mfma_f32_16x16x32_bf16 v[20:23], v[144:147], v[36:39], v[20:23]
    s_waitcnt lgkmcnt(4)
    v_mfma_f32_16x16x32_bf16 v[128:131], v[148:151], v[76:79], v[128:131]
    v_mfma_f32_16x16x32_bf16 v[24:27], v[148:151], v[36:39], v[24:27]
    s_waitcnt lgkmcnt(2)
    v_mfma_f32_16x16x32_bf16 v[132:135], v[152:155], v[76:79], v[132:135]
    v_mfma_f32_16x16x32_bf16 v[40:43], v[152:155], v[36:39], v[40:43]
    s_waitcnt lgkmcnt(0)
    v_mfma_f32_16x16x32_bf16 v[136:139], v[156:159], v[76:79], v[136:139]
    v_mfma_f32_16x16x32_bf16 v[44:47], v[156:159], v[36:39], v[44:47]
    s_cmp_ge_u32 s30, 4
    s_cbranch_scc1 mega_lwd_q1
    v_mov_b32 v12, 163396
    s_mov_b32 s3, 524288
mega_lw_q1:
    ds_read_b32 v13, v12
    s_waitcnt lgkmcnt(0)
    v_readfirstlane_b32 s39, v13
    s_nop 0
    s_cmp_ge_u32 s39, 4
    s_cbranch_scc1 mega_lwd_q1
    s_sleep 1
    s_sub_u32 s3, s3, 1
    s_cbranch_scc0 mega_lw_q1
mega_lwd_q1:
    ds_read_b64_tr_b16 v[140:141], v30 offset:0
    ds_read_b64_tr_b16 v[142:143], v31 offset:0
    ds_read_b64_tr_b16 v[144:145], v30 offset:32
    ds_read_b64_tr_b16 v[146:147], v31 offset:32
    ds_read_b64_tr_b16 v[148:149], v30 offset:64
    ds_read_b64_tr_b16 v[150:151], v31 offset:64
    ds_read_b64_tr_b16 v[152:153], v30 offset:96
    ds_read_b64_tr_b16 v[154:155], v31 offset:96
    ds_read_b64_tr_b16 v[156:157], v30 offset:128
    ds_read_b64_tr_b16 v[158:159], v31 offset:128
    ds_read_b64_tr_b16 v[160:161], v30 offset:5120
    ds_read_b64_tr_b16 v[162:163], v31 offset:5120
    ds_read_b64_tr_b16 v[164:165], v30 offset:5152
    ds_read_b64_tr_b16 v[166:167], v31 offset:5152
    s_waitcnt lgkmcnt(12)
    v_mfma_f32_16x16x32_bf16 v[120:123], v[140:143], v[80:83], v[120:123]
    v_mfma_f32_16x16x32_bf16 v[16:19], v[140:143], v[36:39], v[16:19]
    s_waitcnt lgkmcnt(10)
    v_mfma_f32_16x16x32_bf16 v[124:127], v[144:147], v[80:83], v[124:127]
    ds_read_b64_tr_b16 v[140:141], v30 offset:5184
    v_mfma_f32_16x16x32_bf16 v[20:23], v[144:147], v[36:39], v[20:23]
    ds_read_b64_tr_b16 v[142:143], v31 offset:5184
    s_waitcnt lgkmcnt(10)
    v_mfma_f32_16x16x32_bf16 v[128:131], v[148:151], v[80:83], v[128:131]
    ds_read_b64_tr_b16 v[144:145], v30 offset:5216
    v_mfma_f32_16x16x32_bf16 v[24:27], v[148:151], v[36:39], v[24:27]
    ds_read_b64_tr_b16 v[146:147], v31 offset:5216
    s_waitcnt lgkmcnt(10)
    v_mfma_f32_16x16x32_bf16 v[132:135], v[152:155], v[80:83], v[132:135]
    ds_read_b64_tr_b16 v[148:149], v30 offset:5248
    v_mfma_f32_16x16x32_bf16 v[40:43], v[152:155], v[36:39], v[40:43]
    ds_read_b64_tr_b16 v[150:151], v31 offset:5248
    s_waitcnt lgkmcnt(10)
    v_mfma_f32_16x16x32_bf16 v[136:139], v[156:159], v[80:83], v[136:139]
    ds_read_b64_tr_b16 v[152:153], v30 offset:10240
    v_mfma_f32_16x16x32_bf16 v[44:47], v[156:159], v[36:39], v[44:47]
    ds_read_b64_tr_b16 v[154:155], v31 offset:10240
    s_waitcnt lgkmcnt(10)
    v_mfma_f32_16x16x32_bf16 v[120:123], v[160:163], v[84:87], v[120:123]
    ds_read_b64_tr_b16 v[156:157], v30 offset:10272
    v_mfma_f32_16x16x32_bf16 v[16:19], v[160:163], v[36:39], v[16:19]
    ds_read_b64_tr_b16 v[158:159], v31 offset:10272
    s_waitcnt lgkmcnt(10)
    v_mfma_f32_16x16x32_bf16 v[124:127], v[164:167], v[84:87], v[124:127]
    ds_read_b64_tr_b16 v[160:161], v30 offset:10304
    v_mfma_f32_16x16x32_bf16 v[20:23], v[164:167], v[36:39], v[20:23]
    ds_read_b64_tr_b16 v[162:163], v31 offset:10304
    s_waitcnt lgkmcnt(10)
    v_mfma_f32_16x16x32_bf16 v[128:131], v[140:143], v[84:87], v[128:131]
    ds_read_b64_tr_b16 v[164:165], v30 offset:10336
    v_mfma_f32_16x16x32_bf16 v[24:27], v[140:143], v[36:39], v[24:27]
    ds_read_b64_tr_b16 v[166:167], v31 offset:10336
    s_waitcnt lgkmcnt(10)
    v_mfma_f32_16x16x32_bf16 v[132:135], v[144:147], v[84:87], v[132:135]
    ds_read_b64_tr_b16 v[140:141], v30 offset:10368
    v_mfma_f32_16x16x32_bf16 v[40:43], v[144:147], v[36:39], v[40:43]
    ds_read_b64_tr_b16 v[142:143], v31 offset:10368
    s_waitcnt lgkmcnt(10)
    v_mfma_f32_16x16x32_bf16 v[136:139], v[148:151], v[84:87], v[136:139]
    ds_read_b64_tr_b16 v[144:145], v30 offset:15360
    v_mfma_f32_16x16x32_bf16 v[44:47], v[148:151], v[36:39], v[44:47]
    ds_read_b64_tr_b16 v[146:147], v31 offset:15360
    s_waitcnt lgkmcnt(10)
    v_mfma_f32_16x16x32_bf16 v[120:123], v[152:155], v[88:91], v[120:123]
    ds_read_b64_tr_b16 v[148:149], v30 offset:15392
    v_mfma_f32_16x16x32_bf16 v[16:19], v[152:155], v[36:39], v[16:19]
    ds_read_b64_tr_b16 v[150:151], v31 offset:15392
    s_waitcnt lgkmcnt(10)
    v_mfma_f32_16x16x32_bf16 v[124:127], v[156:159], v[88:91], v[124:127]
    ds_read_b64_tr_b16 v[152:153], v30 offset:15424
    v_mfma_f32_16x16x32_bf16 v[20:23], v[156:159], v[36:39], v[20:23]
    ds_read_b64_tr_b16 v[154:155], v31 offset:15424
    s_waitcnt lgkmcnt(10)
    v_mfma_f32_16x16x32_bf16 v[128:131], v[160:163], v[88:91], v[128:131]
    ds_read_b64_tr_b16 v[156:157], v30 offset:15456
    v_mfma_f32_16x16x32_bf16 v[24:27], v[160:163], v[36:39], v[24:27]
    ds_read_b64_tr_b16 v[158:159], v31 offset:15456
    s_waitcnt lgkmcnt(10)
    v_mfma_f32_16x16x32_bf16 v[132:135], v[164:167], v[88:91], v[132:135]
    ds_read_b64_tr_b16 v[160:161], v30 offset:15488
    v_mfma_f32_16x16x32_bf16 v[40:43], v[164:167], v[36:39], v[40:43]
    ds_read_b64_tr_b16 v[162:163], v31 offset:15488
    s_waitcnt lgkmcnt(10)
    v_mfma_f32_16x16x32_bf16 v[136:139], v[140:143], v[88:91], v[136:139]
    v_mfma_f32_16x16x32_bf16 v[44:47], v[140:143], v[36:39], v[44:47]
    s_waitcnt lgkmcnt(8)
    v_mfma_f32_16x16x32_bf16 v[120:123], v[144:147], v[92:95], v[120:123]
    v_mfma_f32_16x16x32_bf16 v[16:19], v[144:147], v[36:39], v[16:19]
    s_waitcnt lgkmcnt(6)
    v_mfma_f32_16x16x32_bf16 v[124:127], v[148:151], v[92:95], v[124:127]
    v_mfma_f32_16x16x32_bf16 v[20:23], v[148:151], v[36:39], v[20:23]
    s_waitcnt lgkmcnt(4)
    v_mfma_f32_16x16x32_bf16 v[128:131], v[152:155], v[92:95], v[128:131]
    v_mfma_f32_16x16x32_bf16 v[24:27], v[152:155], v[36:39], v[24:27]
    s_waitcnt lgkmcnt(2)
    v_mfma_f32_16x16x32_bf16 v[132:135], v[156:159], v[92:95], v[132:135]
    v_mfma_f32_16x16x32_bf16 v[40:43], v[156:159], v[36:39], v[40:43]
    s_waitcnt lgkmcnt(0)
    v_mfma_f32_16x16x32_bf16 v[136:139], v[160:163], v[92:95], v[136:139]
    v_mfma_f32_16x16x32_bf16 v[44:47], v[160:163], v[36:39], v[44:47]
    s_cmp_ge_u32 s30, 4
    s_cbranch_scc1 mega_lwd_q2
    v_mov_b32 v12, 163400
    s_mov_b32 s3, 524288
mega_lw_q2:
    ds_read_b32 v13, v12
    s_waitcnt lgkmcnt(0)
    v_readfirstlane_b32 s39, v13
    s_nop 0
    s_cmp_ge_u32 s39, 4
    s_cbranch_scc1 mega_lwd_q2
    s_sleep 1
    s_sub_u32 s3, s3, 1
    s_cbranch_scc0 mega_lw_q2
mega_lwd_q2:
    ds_read_b64_tr_b16 v[140:141], v30 offset:20480
    ds_read_b64_tr_b16 v[142:143], v31 offset:20480
    ds_read_b64_tr_b16 v[144:145], v30 offset:20512
    ds_read_b64_tr_b16 v[146:147], v31 offset:20512
    ds_read_b64_tr_b16 v[148:149], v30 offset:20544
    ds_read_b64_tr_b16 v[150:151], v31 offset:20544
    ds_read_b64_tr_b16 v[152:153], v30 offset:20576
    ds_read_b64_tr_b16 v[154:155], v31 offset:20576
    ds_read_b64_tr_b16 v[156:157], v30 offset:20608
    ds_read_b64_tr_b16 v[158:159], v31 offset:20608
    ds_read_b64_tr_b16 v[160:161], v30 offset:25600
    ds_read_b64_tr_b16 v[162:163], v31 offset:25600
    ds_read_b64_tr_b16 v[164:165], v30 offset:25632
    ds_read_b64_tr_b16 v[166:167], v31 offset:25632
    s_waitcnt lgkmcnt(12)
    v_mfma_f32_16x16x32_bf16 v[120:123], v[140:143], v[96:99], v[120:123]
    v_mfma_f32_16x16x32_bf16 v[16:19], v[140:143], v[36:39], v[16:19]
    s_waitcnt lgkmcnt(10)
    v_mfma_f32_16x16x32_bf16 v[124:127], v[144:147], v[96:99], v[124:127]
    ds_read_b64_tr_b16 v[140:141], v30 offset:25664
    v_mfma_f32_16x16x32_bf16 v[20:23], v[144:147], v[36:39], v[20:23]
    ds_read_b64_tr_b16 v[142:143], v31 offset:25664
    s_waitcnt lgkmcnt(10)
    v_mfma_f32_16x16x32_bf16 v[128:131], v[148:151], v[96:99], v[128:131]
    ds_read_b64_tr_b16 v[144:145], v30 offset:25696
    v_mfma_f32_16x16x32_bf16 v[24:27], v[148:151], v[36:39], v[24:27]
    ds_read_b64_tr_b16 v[146:147], v31 offset:25696
    s_waitcnt lgkmcnt(10)
    v_mfma_f32_16x16x32_bf16 v[132:135], v[152:155], v[96:99], v[132:135]
    ds_read_b64_tr_b16 v[148:149], v30 offset:25728
    v_mfma_f32_16x16x32_bf16 v[40:43], v[152:155], v[36:39], v[40:43]
    ds_read_b64_tr_b16 v[150:151], v31 offset:25728
    s_waitcnt lgkmcnt(10)
    v_mfma_f32_16x16x32_bf16 v[136:139], v[156:159], v[96:99], v[136:139]
    ds_read_b64_tr_b16 v[152:153], v30 offset:30720
    v_mfma_f32_16x16x32_bf16 v[44:47], v[156:159], v[36:39], v[44:47]
    ds_read_b64_tr_b16 v[154:155], v31 offset:30720
    s_waitcnt lgkmcnt(10)
    v_mfma_f32_16x16x32_bf16 v[120:123], v[160:163], v[100:103], v[120:123]
    ds_read_b64_tr_b16 v[156:157], v30 offset:30752
    v_mfma_f32_16x16x32_bf16 v[16:19], v[160:163], v[36:39], v[16:19]
    ds_read_b64_tr_b16 v[158:159], v31 offset:30752
    s_waitcnt lgkmcnt(10)
    v_mfma_f32_16x16x32_bf16 v[124:127], v[164:167], v[100:103], v[124:127]
    ds_read_b64_tr_b16 v[160:161], v30 offset:30784
    v_mfma_f32_16x16x32_bf16 v[20:23], v[164:167], v[36:39], v[20:23]
    ds_read_b64_tr_b16 v[162:163], v31 offset:30784
    s_waitcnt lgkmcnt(10)
    v_mfma_f32_16x16x32_bf16 v[128:131], v[140:143], v[100:103], v[128:131]
    ds_read_b64_tr_b16 v[164:165], v30 offset:30816
    v_mfma_f32_16x16x32_bf16 v[24:27], v[140:143], v[36:39], v[24:27]
    ds_read_b64_tr_b16 v[166:167], v31 offset:30816
    s_waitcnt lgkmcnt(10)
    v_mfma_f32_16x16x32_bf16 v[132:135], v[144:147], v[100:103], v[132:135]
    ds_read_b64_tr_b16 v[140:141], v30 offset:30848
    v_mfma_f32_16x16x32_bf16 v[40:43], v[144:147], v[36:39], v[40:43]
    ds_read_b64_tr_b16 v[142:143], v31 offset:30848
    s_waitcnt lgkmcnt(10)
    v_mfma_f32_16x16x32_bf16 v[136:139], v[148:151], v[100:103], v[136:139]
    ds_read_b64_tr_b16 v[144:145], v30 offset:35840
    v_mfma_f32_16x16x32_bf16 v[44:47], v[148:151], v[36:39], v[44:47]
    ds_read_b64_tr_b16 v[146:147], v31 offset:35840
    s_waitcnt lgkmcnt(10)
    v_mfma_f32_16x16x32_bf16 v[120:123], v[152:155], v[104:107], v[120:123]
    ds_read_b64_tr_b16 v[148:149], v30 offset:35872
    v_mfma_f32_16x16x32_bf16 v[16:19], v[152:155], v[36:39], v[16:19]
    ds_read_b64_tr_b16 v[150:151], v31 offset:35872
    s_waitcnt lgkmcnt(10)
    v_mfma_f32_16x16x32_bf16 v[124:127], v[156:159], v[104:107], v[124:127]
    ds_read_b64_tr_b16 v[152:153], v30 offset:35904
    v_mfma_f32_16x16x32_bf16 v[20:23], v[156:159], v[36:39], v[20:23]
    ds_read_b64_tr_b16 v[154:155], v31 offset:35904
    s_waitcnt lgkmcnt(10)
    v_mfma_f32_16x16x32_bf16 v[128:131], v[160:163], v[104:107], v[128:131]
    ds_read_b64_tr_b16 v[156:157], v30 offset:35936
    v_mfma_f32_16x16x32_bf16 v[24:27], v[160:163], v[36:39], v[24:27]
    ds_read_b64_tr_b16 v[158:159], v31 offset:35936
    s_waitcnt lgkmcnt(10)
    v_mfma_f32_16x16x32_bf16 v[132:135], v[164:167], v[104:107], v[132:135]
    ds_read_b64_tr_b16 v[160:161], v30 offset:35968
    v_mfma_f32_16x16x32_bf16 v[40:43], v[164:167], v[36:39], v[40:43]
    ds_read_b64_tr_b16 v[162:163], v31 offset:35968
    s_waitcnt lgkmcnt(10)
    v_mfma_f32_16x16x32_bf16 v[136:139], v[140:143], v[104:107], v[136:139]
    ds_read_b64_tr_b16 v[164:165], v30 offset:40960
    v_mfma_f32_16x16x32_bf16 v[44:47], v[140:143], v[36:39], v[44:47]
    ds_read_b64_tr_b16 v[166:167], v31 offset:40960
    s_waitcnt lgkmcnt(10)
    v_mfma_f32_16x16x32_bf16 v[120:123], v[144:147], v[108:111], v[120:123]
    ds_read_b64_tr_b16 v[140:141], v30 offset:40992
    v_mfma_f32_16x16x32_bf16 v[16:19], v[144:147], v[36:39], v[16:19]
    ds_read_b64_tr_b16 v[142:143], v31 offset:40992
    s_waitcnt lgkmcnt(10)
    v_mfma_f32_16x16x32_bf16 v[124:127], v[148:151], v[108:111], v[124:127]
    ds_read_b64_tr_b16 v[144:145], v30 offset:41024
    v_mfma_f32_16x16x32_bf16 v[20:23], v[148:151], v[36:39], v[20:23]
    ds_read_b64_tr_b16 v[146:147], v31 offset:41024
    s_waitcnt lgkmcnt(10)
    v_mfma_f32_16x16x32_bf16 v[128:131], v[152:155], v[108:111], v[128:131]
    ds_read_b64_tr_b16 v[148:149], v30 offset:41056
    v_mfma_f32_16x16x32_bf16 v[24:27], v[152:155], v[36:39], v[24:27]
    ds_read_b64_tr_b16 v[150:151], v31 offset:41056
    s_waitcnt lgkmcnt(10)
    v_mfma_f32_16x16x32_bf16 v[132:135], v[156:159], v[108:111], v[132:135]
    ds_read_b64_tr_b16 v[152:153], v30 offset:41088
    v_mfma_f32_16x16x32_bf16 v[40:43], v[156:159], v[36:39], v[40:43]
    ds_read_b64_tr_b16 v[154:155], v31 offset:41088
    s_waitcnt lgkmcnt(10)
    v_mfma_f32_16x16x32_bf16 v[136:139], v[160:163], v[108:111], v[136:139]
    ds_read_b64_tr_b16 v[156:157], v30 offset:46080
    v_mfma_f32_16x16x32_bf16 v[44:47], v[160:163], v[36:39], v[44:47]
    ds_read_b64_tr_b16 v[158:159], v31 offset:46080
    s_waitcnt lgkmcnt(10)
    v_mfma_f32_16x16x32_bf16 v[120:123], v[164:167], v[112:115], v[120:123]
    ds_read_b64_tr_b16 v[160:161], v30 offset:46112
    v_mfma_f32_16x16x32_bf16 v[16:19], v[164:167], v[36:39], v[16:19]
    ds_read_b64_tr_b16 v[162:163], v31 offset:46112
    s_waitcnt lgkmcnt(10)
    v_mfma_f32_16x16x32_bf16 v[124:127], v[140:143], v[112:115], v[124:127]
    ds_read_b64_tr_b16 v[164:165], v30 offset:46144
    v_mfma_f32_16x16x32_bf16 v[20:23], v[140:143], v[36:39], v[20:23]
    ds_read_b64_tr_b16 v[166:167], v31 offset:46144
    s_waitcnt lgkmcnt(10)
    v_mfma_f32_16x16x32_bf16 v[128:131], v[144:147], v[112:115], v[128:131]
    ds_read_b64_tr_b16 v[140:141], v30 offset:46176
    v_mfma_f32_16x16x32_bf16 v[24:27], v[144:147], v[36:39], v[24:27]
    ds_read_b64_tr_b16 v[142:143], v31 offset:46176
    s_waitcnt lgkmcnt(10)
    v_mfma_f32_16x16x32_bf16 v[132:135], v[148:151], v[112:115], v[132:135]
    ds_read_b64_tr_b16 v[144:145], v30 offset:46208
    v_mfma_f32_16x16x32_bf16 v[40:43], v[148:151], v[36:39], v[40:43]
    ds_read_b64_tr_b16 v[146:147], v31 offset:46208
    s_waitcnt lgkmcnt(10)
    v_mfma_f32_16x16x32_bf16 v[136:139], v[152:155], v[112:115], v[136:139]
    v_mfma_f32_16x16x32_bf16 v[44:47], v[152:155], v[36:39], v[44:47]
    s_waitcnt lgkmcnt(8)
    v_mfma_f32_16x16x32_bf16 v[120:123], v[156:159], v[116:119], v[120:123]
    v_mfma_f32_16x16x32_bf16 v[16:19], v[156:159], v[36:39], v[16:19]
    s_waitcnt lgkmcnt(6)
    v_mfma_f32_16x16x32_bf16 v[124:127], v[160:163], v[116:119], v[124:127]
    v_mfma_f32_16x16x32_bf16 v[20:23], v[160:163], v[36:39], v[20:23]
    s_waitcnt lgkmcnt(4)
    v_mfma_f32_16x16x32_bf16 v[128:131], v[164:167], v[116:119], v[128:131]
    v_mfma_f32_16x16x32_bf16 v[24:27], v[164:167], v[36:39], v[24:27]
    s_waitcnt lgkmcnt(2)
    v_mfma_f32_16x16x32_bf16 v[132:135], v[140:143], v[116:119], v[132:135]
    v_mfma_f32_16x16x32_bf16 v[40:43], v[140:143], v[36:39], v[40:43]
    s_waitcnt lgkmcnt(0)
    v_mfma_f32_16x16x32_bf16 v[136:139], v[144:147], v[116:119], v[136:139]
    v_mfma_f32_16x16x32_bf16 v[44:47], v[144:147], v[36:39], v[44:47]
    s_cmp_ge_u32 s30, 4
    s_cbranch_scc1 a_s_done
    s_setprio 3
    v_mov_b32 v12, 163464
    v_mov_b32 v13, 1
    s_mov_b32 exec_lo, 0x1
    s_mov_b32 exec_hi, 0x0
    ds_add_u32 v12, v13
    s_mov_b64 exec, -1
    v_fma_f32 v120, -v6, v16, v120
    v_fma_f32 v121, -v6, v17, v121
    v_fma_f32 v122, -v6, v18, v122
    v_fma_f32 v123, -v6, v19, v123
    v_mul_f32 v120, v34, v120
    v_mul_f32 v121, v34, v121
    v_mul_f32 v122, v34, v122
    v_mul_f32 v123, v34, v123
    v_cvt_pk_bf16_f32 v140, v120, v121
    v_cvt_pk_bf16_f32 v141, v122, v123
    ds_write_b64 v35, v[140:141] offset:0
    v_fma_f32 v124, -v6, v20, v124
    v_fma_f32 v125, -v6, v21, v125
    v_fma_f32 v126, -v6, v22, v126
    v_fma_f32 v127, -v6, v23, v127
    v_mul_f32 v124, v34, v124
    v_mul_f32 v125, v34, v125
    v_mul_f32 v126, v34, v126
    v_mul_f32 v127, v34, v127
    v_cvt_pk_bf16_f32 v142, v124, v125
    v_cvt_pk_bf16_f32 v143, v126, v127
    ds_write_b64 v35, v[142:143] offset:512
    v_fma_f32 v128, -v6, v24, v128
    v_fma_f32 v129, -v6, v25, v129
    v_fma_f32 v130, -v6, v26, v130
    v_fma_f32 v131, -v6, v27, v131
    v_mul_f32 v128, v34, v128
    v_mul_f32 v129, v34, v129
    v_mul_f32 v130, v34, v130
    v_mul_f32 v131, v34, v131
    v_cvt_pk_bf16_f32 v144, v128, v129
    v_cvt_pk_bf16_f32 v145, v130, v131
    ds_write_b64 v35, v[144:145] offset:1024
    v_fma_f32 v132, -v6, v40, v132
    v_fma_f32 v133, -v6, v41, v133
    v_fma_f32 v134, -v6, v42, v134
    v_fma_f32 v135, -v6, v43, v135
    v_mul_f32 v132, v34, v132
    v_mul_f32 v133, v34, v133
    v_mul_f32 v134, v34, v134
    v_mul_f32 v135, v34, v135
    v_cvt_pk_bf16_f32 v146, v132, v133
    v_cvt_pk_bf16_f32 v147, v134, v135
    ds_write_b64 v35, v[146:147] offset:1536
    v_fma_f32 v136, -v6, v44, v136
    v_fma_f32 v137, -v6, v45, v137
    v_fma_f32 v138, -v6, v46, v138
    v_fma_f32 v139, -v6, v47, v139
    v_mul_f32 v136, v34, v136
    v_mul_f32 v137, v34, v137
    v_mul_f32 v138, v34, v138
    v_mul_f32 v139, v34, v139
    v_cvt_pk_bf16_f32 v148, v136, v137
    v_cvt_pk_bf16_f32 v149, v138, v139
    s_mov_b32 exec_lo, 0xffffffff
    s_mov_b32 exec_hi, 0x0
    ds_write_b64 v35, v[148:149] offset:2048
    s_lshr_b32 s35, s30, 1
    s_lshl_b32 s35, s35, 2
    s_add_u32 s35, s35, 163456
    v_mov_b32 v12, s35
    v_mov_b32 v13, 1
    s_mov_b32 exec_lo, 0x1
    s_mov_b32 exec_hi, 0x0
    ds_add_u32 v12, v13
    s_mov_b64 exec, -1
    s_branch a_done
a_kvw:
    s_setprio 3
    s_cmp_lt_u32 s29, 4
    s_cselect_b32 s20, s70, s72
    s_cselect_b32 s21, s71, s73
    s_mov_b32 s22, 20736
    s_mov_b32 s23, 0x00020000
    s_movk_i32 s40, 21846
    v_add_u32 v32, 0, v1
    v_mul_u32_u24 v33, s40, v32
    v_lshrrev_b32 v33, 16, v33
    v_mul_u32_u24 v34, 3, v33
    v_sub_u32 v34, v32, v34
    v_lshlrev_b32 v34, 4, v34
    v_min_u32 v34, 20, v34
    v_and_b32 v35, 8, v33
    v_lshrrev_b32 v35, 1, v35
    v_xor_b32 v35, v35, v33
    v_mad_u32_u24 v16, v35, 36, v34
    v_add_u32 v32, 64, v1
    v_mul_u32_u24 v33, s40, v32
    v_lshrrev_b32 v33, 16, v33
    v_mul_u32_u24 v34, 3, v33
    v_sub_u32 v34, v32, v34
    v_lshlrev_b32 v34, 4, v34
    v_min_u32 v34, 20, v34
    v_and_b32 v35, 8, v33
    v_lshrrev_b32 v35, 1, v35
    v_xor_b32 v35, v35, v33
    v_mad_u32_u24 v17, v35, 36, v34
    v_add_u32 v32, 128, v1
    v_mul_u32_u24 v33, s40, v32
    v_lshrrev_b32 v33, 16, v33
    v_mul_u32_u24 v34, 3, v33
    v_sub_u32 v34, v32, v34
    v_lshlrev_b32 v34, 4, v34
    v_min_u32 v34, 20, v34
    v_and_b32 v35, 8, v33
    v_lshrrev_b32 v35, 1, v35
    v_xor_b32 v35, v35, v33
    v_mad_u32_u24 v18, v35, 36, v34
    s_sub_u32 s34, s30, 4
    s_mul_i32 s34, s34, 3
    s_mul_i32 s43, s34, 3072
    s_lshr_b32 s35, s48, 1
    s_add_u32 s35, s35, s34
    s_sub_u32 s36, s35, 9
    s_min_u32 s35, s35, s36
    s_mul_i32 s35, s35, 2304
    s_add_u32 m0, s43, 0
    s_nop 0
    buffer_load_dwordx4 v16, s[20:23], s35 offen lds
    s_add_u32 m0, s43, 1024
    s_nop 0
    buffer_load_dwordx4 v17, s[20:23], s35 offen lds
    s_add_u32 m0, s43, 2048
    s_nop 0
    buffer_load_dwordx4 v18, s[20:23], s35 offen lds
    s_add_u32 s35, s35, 2304
    s_cmp_eq_u32 s35, 20736
    s_cselect_b32 s35, 0, s35
    s_add_u32 m0, s43, 3072
    s_nop 0
    buffer_load_dwordx4 v16, s[20:23], s35 offen lds
    s_add_u32 m0, s43, 4096
    s_nop 0
    buffer_load_dwordx4 v17, s[20:23], s35 offen lds
    s_add_u32 m0, s43, 5120
    s_nop 0
    buffer_load_dwordx4 v18, s[20:23], s35 offen lds
    s_add_u32 s35, s35, 2304
    s_cmp_eq_u32 s35, 20736
    s_cselect_b32 s35, 0, s35
    s_add_u32 m0, s43, 6144
    s_nop 0
    buffer_load_dwordx4 v16, s[20:23], s35 offen lds
    s_add_u32 m0, s43, 7168
    s_nop 0
    buffer_load_dwordx4 v17, s[20:23], s35 offen lds
    s_add_u32 m0, s43, 8192
    s_nop 0
    buffer_load_dwordx4 v18, s[20:23], s35 offen lds
    s_add_u32 s35, s35, 2304
    s_cmp_eq_u32 s35, 20736
    s_cselect_b32 s35, 0, s35
    s_barrier
    v_lshrrev_b32 v32, 2, v2
    v_and_b32 v33, 1, v3
    v_lshlrev_b32 v33, 2, v33
    v_add_u32 v32, v32, v33
    v_lshl_add_u32 v32, v3, 3, v32
    v_xor_b32 v33, 4, v32
    s_movk_i32 s40, 48
    v_and_b32 v34, 3, v2
    v_lshlrev_b32 v34, 3, v34
    v_add_u32 v34, 0, v34
    v_mad_u32_u24 v28, v32, s40, v34
    v_mad_u32_u24 v29, v33, s40, v34
    v_lshrrev_b32 v35, 2, v2
    v_sub_u32 v35, 4, v35
    v_and_b32 v35, 3, v35
    v_xor_b32 v35, v35, v3
    v_lshlrev_b32 v35, 4, v35
    v_lshl_add_u32 v35, v2, 6, v35
    v_add_u32 v35, 70656, v35
    v_mov_b32 v120, 0
    v_mov_b32 v121, 0
    v_mov_b32 v122, 0
    v_mov_b32 v123, 0
    v_mov_b32 v124, 0
    v_mov_b32 v125, 0
    v_mov_b32 v126, 0
    v_mov_b32 v127, 0
    s_lshr_b32 s41, s28, 1
    s_mul_i32 s41, s41, 9488
    s_add_u32 s41, s41, 45481984
    s_and_b32 s42, s28, 1
    s_lshl_b32 s42, s42, 1
    s_bfe_u32 s43, s29, 0x10001
    s_add_u32 s42, s42, s43
    s_and_b32 s43, s29, 1
    s_lshl_b32 s49, s28, 7
    s_lshl_b32 s34, s29, 3
    s_add_u32 s49, s49, s34
    s_add_u32 s49, s49, 7110656
    s_waitcnt vmcnt(0)
    v_mov_b32 v12, 163424
    v_mov_b32 v13, 1
    s_mov_b32 exec_lo, 0x1
    s_mov_b32 exec_hi, 0x0
    ds_add_u32 v12, v13
    s_mov_b64 exec, -1
    v_mov_b32 v12, 163416
    s_mov_b32 s3, 524288
mega_lw_kvi:
    ds_read_b32 v13, v12
    s_waitcnt lgkmcnt(0)
    v_readfirstlane_b32 s39, v13
    s_nop 0
    s_cmp_ge_u32 s39, 3
    s_cbranch_scc1 mega_lwd_kvi
    s_sleep 1
    s_sub_u32 s3, s3, 1
    s_cbranch_scc0 mega_lw_kvi
mega_lwd_kvi:
    s_cmp_ge_u32 s29, 4
    s_cbranch_scc1 a_kv_v
    ds_read_b128 v[48:51], v35 offset:0
    ds_read_b64_tr_b16 v[60:61], v28 offset:0
    ds_read_b64_tr_b16 v[62:63], v29 offset:0
    ds_read_b64_tr_b16 v[64:65], v28 offset:32
    ds_read_b64_tr_b16 v[66:67], v29 offset:32
    ds_read_b128 v[52:55], v35 offset:1024
    ds_read_b64_tr_b16 v[68:69], v28 offset:1536
    ds_read_b64_tr_b16 v[70:71], v29 offset:1536
    ds_read_b64_tr_b16 v[72:73], v28 offset:1568
    ds_read_b64_tr_b16 v[74:75], v29 offset:1568
    ds_read_b128 v[56:59], v35 offset:2048
    ds_read_b64_tr_b16 v[76:77], v28 offset:3072
    ds_read_b64_tr_b16 v[78:79], v29 offset:3072
    ds_read_b64_tr_b16 v[80:81], v28 offset:3104
    ds_read_b64_tr_b16 v[82:83], v29 offset:3104
    s_waitcnt lgkmcnt(10)
    v_mfma_f32_16x16x32_bf16 v[120:123], v[60:63], v[48:51], v[120:123]
    v_mfma_f32_16x16x32_bf16 v[124:127], v[64:67], v[48:51], v[124:127]
    ds_read_b128 v[48:51], v35 offset:3072
    ds_read_b64_tr_b16 v[60:61], v28 offset:4608
    ds_read_b64_tr_b16 v[62:63], v29 offset:4608
    ds_read_b64_tr_b16 v[64:65], v28 offset:4640
    ds_read_b64_tr_b16 v[66:67], v29 offset:4640
    s_waitcnt lgkmcnt(10)
    v_mfma_f32_16x16x32_bf16 v[120:123], v[68:71], v[52:55], v[120:123]
    v_mfma_f32_16x16x32_bf16 v[124:127], v[72:75], v[52:55], v[124:127]
    ds_read_b128 v[52:55], v35 offset:4096
    ds_read_b64_tr_b16 v[68:69], v28 offset:6144
    ds_read_b64_tr_b16 v[70:71], v29 offset:6144
    ds_read_b64_tr_b16 v[72:73], v28 offset:6176
    ds_read_b64_tr_b16 v[74:75], v29 offset:6176
    s_waitcnt lgkmcnt(10)
    v_mfma_f32_16x16x32_bf16 v[120:123], v[76:79], v[56:59], v[120:123]
    v_mfma_f32_16x16x32_bf16 v[124:127], v[80:83], v[56:59], v[124:127]
    ds_read_b128 v[56:59], v35 offset:5120
    ds_read_b64_tr_b16 v[76:77], v28 offset:7680
    ds_read_b64_tr_b16 v[78:79], v29 offset:7680
    ds_read_b64_tr_b16 v[80:81], v28 offset:7712
    ds_read_b64_tr_b16 v[82:83], v29 offset:7712
    s_waitcnt lgkmcnt(10)
    v_mfma_f32_16x16x32_bf16 v[120:123], v[60:63], v[48:51], v[120:123]
    v_mfma_f32_16x16x32_bf16 v[124:127], v[64:67], v[48:51], v[124:127]
    ds_read_b128 v[48:51], v35 offset:6144
    ds_read_b64_tr_b16 v[60:61], v28 offset:9216
    ds_read_b64_tr_b16 v[62:63], v29 offset:9216
    ds_read_b64_tr_b16 v[64:65], v28 offset:9248
    ds_read_b64_tr_b16 v[66:67], v29 offset:9248
    s_waitcnt lgkmcnt(10)
    v_mfma_f32_16x16x32_bf16 v[120:123], v[68:71], v[52:55], v[120:123]
    v_mfma_f32_16x16x32_bf16 v[124:127], v[72:75], v[52:55], v[124:127]
    ds_read_b128 v[52:55], v35 offset:7168
    ds_read_b64_tr_b16 v[68:69], v28 offset:10752
    ds_read_b64_tr_b16 v[70:71], v29 offset:10752
    ds_read_b64_tr_b16 v[72:73], v28 offset:10784
    ds_read_b64_tr_b16 v[74:75], v29 offset:10784
    s_waitcnt lgkmcnt(10)
    v_mfma_f32_16x16x32_bf16 v[120:123], v[76:79], v[56:59], v[120:123]
    v_mfma_f32_16x16x32_bf16 v[124:127], v[80:83], v[56:59], v[124:127]
    ds_read_b128 v[56:59], v35 offset:8192
    ds_read_b64_tr_b16 v[76:77], v28 offset:12288
    ds_read_b64_tr_b16 v[78:79], v29 offset:12288
    ds_read_b64_tr_b16 v[80:81], v28 offset:12320
    ds_read_b64_tr_b16 v[82:83], v29 offset:12320
    s_waitcnt lgkmcnt(10)
    v_mfma_f32_16x16x32_bf16 v[120:123], v[60:63], v[48:51], v[120:123]
    v_mfma_f32_16x16x32_bf16 v[124:127], v[64:67], v[48:51], v[124:127]
    ds_read_b128 v[48:51], v35 offset:9216
    ds_read_b64_tr_b16 v[60:61], v28 offset:13824
    ds_read_b64_tr_b16 v[62:63], v29 offset:13824
    ds_read_b64_tr_b16 v[64:65], v28 offset:13856
    ds_read_b64_tr_b16 v[66:67], v29 offset:13856
    s_waitcnt lgkmcnt(10)
    v_mfma_f32_16x16x32_bf16 v[120:123], v[68:71], v[52:55], v[120:123]
    v_mfma_f32_16x16x32_bf16 v[124:127], v[72:75], v[52:55], v[124:127]
    ds_read_b128 v[52:55], v35 offset:10240
    ds_read_b64_tr_b16 v[68:69], v28 offset:15360
    ds_read_b64_tr_b16 v[70:71], v29 offset:15360
    ds_read_b64_tr_b16 v[72:73], v28 offset:15392
    ds_read_b64_tr_b16 v[74:75], v29 offset:15392
    s_waitcnt lgkmcnt(10)
    v_mfma_f32_16x16x32_bf16 v[120:123], v[76:79], v[56:59], v[120:123]
    v_mfma_f32_16x16x32_bf16 v[124:127], v[80:83], v[56:59], v[124:127]
    ds_read_b128 v[56:59], v35 offset:11264
    ds_read_b64_tr_b16 v[76:77], v28 offset:16896
    ds_read_b64_tr_b16 v[78:79], v29 offset:16896
    ds_read_b64_tr_b16 v[80:81], v28 offset:16928
    ds_read_b64_tr_b16 v[82:83], v29 offset:16928
    s_waitcnt lgkmcnt(10)
    v_mfma_f32_16x16x32_bf16 v[120:123], v[60:63], v[48:51], v[120:123]
    v_mfma_f32_16x16x32_bf16 v[124:127], v[64:67], v[48:51], v[124:127]
    ds_read_b128 v[48:51], v35 offset:12288
    ds_read_b64_tr_b16 v[60:61], v28 offset:18432
    ds_read_b64_tr_b16 v[62:63], v29 offset:18432
    ds_read_b64_tr_b16 v[64:65], v28 offset:18464
    ds_read_b64_tr_b16 v[66:67], v29 offset:18464
    s_waitcnt lgkmcnt(10)
    v_mfma_f32_16x16x32_bf16 v[120:123], v[68:71], v[52:55], v[120:123]
    v_mfma_f32_16x16x32_bf16 v[124:127], v[72:75], v[52:55], v[124:127]
    ds_read_b128 v[52:55], v35 offset:13312
    ds_read_b64_tr_b16 v[68:69], v28 offset:19968
    ds_read_b64_tr_b16 v[70:71], v29 offset:19968
    ds_read_b64_tr_b16 v[72:73], v28 offset:20000
    ds_read_b64_tr_b16 v[74:75], v29 offset:20000
    s_waitcnt lgkmcnt(10)
    v_mfma_f32_16x16x32_bf16 v[120:123], v[76:79], v[56:59], v[120:123]
    v_mfma_f32_16x16x32_bf16 v[124:127], v[80:83], v[56:59], v[124:127]
    ds_read_b128 v[56:59], v35 offset:14336
    ds_read_b64_tr_b16 v[76:77], v28 offset:21504
    ds_read_b64_tr_b16 v[78:79], v29 offset:21504
    ds_read_b64_tr_b16 v[80:81], v28 offset:21536
    ds_read_b64_tr_b16 v[82:83], v29 offset:21536
    s_waitcnt lgkmcnt(10)
    v_mfma_f32_16x16x32_bf16 v[120:123], v[60:63], v[48:51], v[120:123]
    v_mfma_f32_16x16x32_bf16 v[124:127], v[64:67], v[48:51], v[124:127]
    ds_read_b128 v[48:51], v35 offset:15360
    ds_read_b64_tr_b16 v[60:61], v28 offset:23040
    ds_read_b64_tr_b16 v[62:63], v29 offset:23040
    ds_read_b64_tr_b16 v[64:65], v28 offset:23072
    ds_read_b64_tr_b16 v[66:67], v29 offset:23072
    s_waitcnt lgkmcnt(10)
    v_mfma_f32_16x16x32_bf16 v[120:123], v[68:71], v[52:55], v[120:123]
    v_mfma_f32_16x16x32_bf16 v[124:127], v[72:75], v[52:55], v[124:127]
    ds_read_b128 v[52:55], v35 offset:16384
    ds_read_b64_tr_b16 v[68:69], v28 offset:24576
    ds_read_b64_tr_b16 v[70:71], v29 offset:24576
    ds_read_b64_tr_b16 v[72:73], v28 offset:24608
    ds_read_b64_tr_b16 v[74:75], v29 offset:24608
    s_waitcnt lgkmcnt(10)
    v_mfma_f32_16x16x32_bf16 v[120:123], v[76:79], v[56:59], v[120:123]
    v_mfma_f32_16x16x32_bf16 v[124:127], v[80:83], v[56:59], v[124:127]
    ds_read_b128 v[56:59], v35 offset:17408
    ds_read_b64_tr_b16 v[76:77], v28 offset:26112
    ds_read_b64_tr_b16 v[78:79], v29 offset:26112
    ds_read_b64_tr_b16 v[80:81], v28 offset:26144
    ds_read_b64_tr_b16 v[82:83], v29 offset:26144
    s_waitcnt lgkmcnt(10)
    v_mfma_f32_16x16x32_bf16 v[120:123], v[60:63], v[48:51], v[120:123]
    v_mfma_f32_16x16x32_bf16 v[124:127], v[64:67], v[48:51], v[124:127]
    s_waitcnt lgkmcnt(5)
    v_mfma_f32_16x16x32_bf16 v[120:123], v[68:71], v[52:55], v[120:123]
    v_mfma_f32_16x16x32_bf16 v[124:127], v[72:75], v[52:55], v[124:127]
    s_waitcnt lgkmcnt(0)
    v_mfma_f32_16x16x32_bf16 v[120:123], v[76:79], v[56:59], v[120:123]
    v_mfma_f32_16x16x32_bf16 v[124:127], v[80:83], v[56:59], v[124:127]
    v_mov_b32 v12, 163404
    s_mov_b32 s3, 524288
mega_lw_kvk:
    ds_read_b32 v13, v12
    s_waitcnt lgkmcnt(0)
    v_readfirstlane_b32 s39, v13
    s_nop 0
    s_cmp_ge_u32 s39, 2
    s_cbranch_scc1 mega_lwd_kvk
    s_sleep 1
    s_sub_u32 s3, s3, 1
    s_cbranch_scc0 mega_lw_kvk
mega_lwd_kvk:
    v_lshlrev_b32 v32, 4, v3
    v_add_u32 v32, 161344, v32
    v_lshlrev_b32 v33, 2, v2
    v_add_u32 v33, 161472, v33
    ds_read_b128 v[16:19], v32
    ds_read_b128 v[20:23], v32 offset:64
    ds_read_b32 v6, v33
    ds_read_b32 v7, v33 offset:64
    s_lshl_b32 s38, s43, 8
    v_lshlrev_b32 v36, 4, v2
    v_add_u32 v36, s38, v36
    v_lshrrev_b32 v37, 1, v3
    v_lshl_add_u32 v37, v37, 9, v36
    s_lshl_b32 s38, s42, 10
    s_add_u32 s38, s38, s41
    s_lshl_b32 s39, s42, 2
    s_add_u32 s39, s39, s41
    s_add_u32 s39, s39, 8960
    s_waitcnt lgkmcnt(0)
    v_fma_f32 v120, -v6, v16, v120
    v_fma_f32 v121, -v6, v17, v121
    v_fma_f32 v122, -v6, v18, v122
    v_fma_f32 v123, -v6, v19, v123
    v_fma_f32 v124, -v6, v20, v124
    v_fma_f32 v125, -v6, v21, v125
    v_fma_f32 v126, -v6, v22, v126
    v_fma_f32 v127, -v6, v23, v127
    v_mul_f32 v120, v7, v120
    v_mul_f32 v121, v7, v121
    v_mul_f32 v122, v7, v122
    v_mul_f32 v123, v7, v123
    v_mul_f32 v124, v7, v124
    v_mul_f32 v125, v7, v125
    v_mul_f32 v126, v7, v126
    v_mul_f32 v127, v7, v127
    v_cvt_pk_bf16_f32 v40, v120, v121
    v_cvt_pk_bf16_f32 v41, v122, v123
    v_cvt_pk_bf16_f32 v44, v126, v127
    v_permlane16_swap_b32 v40, v42
    v_permlane16_swap_b32 v41, v43
    s_mov_b32 exec_lo, 0xffff
    s_mov_b32 exec_hi, 0xffff
    buffer_store_dwordx4 v[40:43], v37, s[16:19], s38 offen sc1
    s_mov_b32 exec_lo, 0xffff0000
    s_mov_b32 exec_hi, 0x0
    buffer_store_dword v44, v36, s[16:19], s39 offen sc1
    s_mov_b64 exec, -1
    s_or_b32 s39, s42, s28
    s_cmp_lg_u32 s39, 0
    s_cbranch_scc1 a_kv_nod
    s_add_u32 s38, s38, 151808
    s_mov_b32 exec_lo, 0xffff
    s_mov_b32 exec_hi, 0xffff
    buffer_store_dwordx4 v[40:43], v37, s[16:19], s38 offen sc1
    s_mov_b64 exec, -1
a_kv_nod:
    s_or_b32 s38, s42, s43
    s_cmp_lg_u32 s38, 0
    s_cbranch_scc1 a_kv_noc
    v_mov_b32 v24, 0x3f803f80
    v_mov_b32 v25, 0x00003f80
    v_mov_b32 v26, 0x3f803f80
    v_mov_b32 v27, 0x00003f80
    v_mov_b32 v12, 0
    s_add_u32 s38, s41, 9472
    s_mov_b32 exec_lo, 0x1
    s_mov_b32 exec_hi, 0x0
    buffer_store_dwordx4 v[24:27], v12, s[16:19], s38 offen sc1
    s_mov_b64 exec, -1
a_kv_noc:
    v_mul_f32 v45, v126, v126
    v_fmac_f32 v45, v127, v127
    v_cmp_eq_u32 vcc, 1, v3
    s_nop 1
    v_cndmask_b32 v45, 0, v45, vcc
    v_fmac_f32 v45, v120, v120
    v_fmac_f32 v45, v121, v121
    v_fmac_f32 v45, v122, v122
    v_fmac_f32 v45, v123, v123
    v_mov_b32 v46, v45
    s_nop 1
    v_permlane16_swap_b32 v45, v46
    v_add_f32 v45, v45, v46
    v_mov_b32 v46, v45
    s_nop 1
    v_permlane32_swap_b32 v45, v46
    v_add_f32 v45, v45, v46
    s_nop 1
    v_max_f32_dpp v45, v45, v45 row_ror:8 row_mask:0xf bank_mask:0xf
    s_nop 1
    v_max_f32_dpp v45, v45, v45 row_ror:4 row_mask:0xf bank_mask:0xf
    s_nop 1
    v_max_f32_dpp v45, v45, v45 row_ror:2 row_mask:0xf bank_mask:0xf
    s_nop 1
    v_max_f32_dpp v45, v45, v45 row_ror:1 row_mask:0xf bank_mask:0xf
    s_branch a_kv_pub
a_kv_v:
    ds_read_b128 v[48:51], v35 offset:0
    ds_read_b64_tr_b16 v[60:61], v28 offset:0
    ds_read_b64_tr_b16 v[62:63], v29 offset:0
    ds_read_b64_tr_b16 v[64:65], v28 offset:32
    ds_read_b64_tr_b16 v[66:67], v29 offset:32
    ds_read_b128 v[52:55], v35 offset:1024
    ds_read_b64_tr_b16 v[68:69], v28 offset:1536
    ds_read_b64_tr_b16 v[70:71], v29 offset:1536
    ds_read_b64_tr_b16 v[72:73], v28 offset:1568
    ds_read_b64_tr_b16 v[74:75], v29 offset:1568
    ds_read_b128 v[56:59], v35 offset:2048
    ds_read_b64_tr_b16 v[76:77], v28 offset:3072
    ds_read_b64_tr_b16 v[78:79], v29 offset:3072
    ds_read_b64_tr_b16 v[80:81], v28 offset:3104
    ds_read_b64_tr_b16 v[82:83], v29 offset:3104
    s_waitcnt lgkmcnt(10)
    v_mfma_f32_16x16x32_bf16 v[120:123], v[48:51], v[60:63], v[120:123]
    v_mfma_f32_16x16x32_bf16 v[124:127], v[48:51], v[64:67], v[124:127]
    ds_read_b128 v[48:51], v35 offset:3072
    ds_read_b64_tr_b16 v[60:61], v28 offset:4608
    ds_read_b64_tr_b16 v[62:63], v29 offset:4608
    ds_read_b64_tr_b16 v[64:65], v28 offset:4640
    ds_read_b64_tr_b16 v[66:67], v29 offset:4640
    s_waitcnt lgkmcnt(10)
    v_mfma_f32_16x16x32_bf16 v[120:123], v[52:55], v[68:71], v[120:123]
    v_mfma_f32_16x16x32_bf16 v[124:127], v[52:55], v[72:75], v[124:127]
    ds_read_b128 v[52:55], v35 offset:4096
    ds_read_b64_tr_b16 v[68:69], v28 offset:6144
    ds_read_b64_tr_b16 v[70:71], v29 offset:6144
    ds_read_b64_tr_b16 v[72:73], v28 offset:6176
    ds_read_b64_tr_b16 v[74:75], v29 offset:6176
    s_waitcnt lgkmcnt(10)
    v_mfma_f32_16x16x32_bf16 v[120:123], v[56:59], v[76:79], v[120:123]
    v_mfma_f32_16x16x32_bf16 v[124:127], v[56:59], v[80:83], v[124:127]
    ds_read_b128 v[56:59], v35 offset:5120
    ds_read_b64_tr_b16 v[76:77], v28 offset:7680
    ds_read_b64_tr_b16 v[78:79], v29 offset:7680
    ds_read_b64_tr_b16 v[80:81], v28 offset:7712
    ds_read_b64_tr_b16 v[82:83], v29 offset:7712
    s_waitcnt lgkmcnt(10)
    v_mfma_f32_16x16x32_bf16 v[120:123], v[48:51], v[60:63], v[120:123]
    v_mfma_f32_16x16x32_bf16 v[124:127], v[48:51], v[64:67], v[124:127]
    ds_read_b128 v[48:51], v35 offset:6144
    ds_read_b64_tr_b16 v[60:61], v28 offset:9216
    ds_read_b64_tr_b16 v[62:63], v29 offset:9216
    ds_read_b64_tr_b16 v[64:65], v28 offset:9248
    ds_read_b64_tr_b16 v[66:67], v29 offset:9248
    s_waitcnt lgkmcnt(10)
    v_mfma_f32_16x16x32_bf16 v[120:123], v[52:55], v[68:71], v[120:123]
    v_mfma_f32_16x16x32_bf16 v[124:127], v[52:55], v[72:75], v[124:127]
    ds_read_b128 v[52:55], v35 offset:7168
    ds_read_b64_tr_b16 v[68:69], v28 offset:10752
    ds_read_b64_tr_b16 v[70:71], v29 offset:10752
    ds_read_b64_tr_b16 v[72:73], v28 offset:10784
    ds_read_b64_tr_b16 v[74:75], v29 offset:10784
    s_waitcnt lgkmcnt(10)
    v_mfma_f32_16x16x32_bf16 v[120:123], v[56:59], v[76:79], v[120:123]
    v_mfma_f32_16x16x32_bf16 v[124:127], v[56:59], v[80:83], v[124:127]
    ds_read_b128 v[56:59], v35 offset:8192
    ds_read_b64_tr_b16 v[76:77], v28 offset:12288
    ds_read_b64_tr_b16 v[78:79], v29 offset:12288
    ds_read_b64_tr_b16 v[80:81], v28 offset:12320
    ds_read_b64_tr_b16 v[82:83], v29 offset:12320
    s_waitcnt lgkmcnt(10)
    v_mfma_f32_16x16x32_bf16 v[120:123], v[48:51], v[60:63], v[120:123]
    v_mfma_f32_16x16x32_bf16 v[124:127], v[48:51], v[64:67], v[124:127]
    ds_read_b128 v[48:51], v35 offset:9216
    ds_read_b64_tr_b16 v[60:61], v28 offset:13824
    ds_read_b64_tr_b16 v[62:63], v29 offset:13824
    ds_read_b64_tr_b16 v[64:65], v28 offset:13856
    ds_read_b64_tr_b16 v[66:67], v29 offset:13856
    s_waitcnt lgkmcnt(10)
    v_mfma_f32_16x16x32_bf16 v[120:123], v[52:55], v[68:71], v[120:123]
    v_mfma_f32_16x16x32_bf16 v[124:127], v[52:55], v[72:75], v[124:127]
    ds_read_b128 v[52:55], v35 offset:10240
    ds_read_b64_tr_b16 v[68:69], v28 offset:15360
    ds_read_b64_tr_b16 v[70:71], v29 offset:15360
    ds_read_b64_tr_b16 v[72:73], v28 offset:15392
    ds_read_b64_tr_b16 v[74:75], v29 offset:15392
    s_waitcnt lgkmcnt(10)
    v_mfma_f32_16x16x32_bf16 v[120:123], v[56:59], v[76:79], v[120:123]
    v_mfma_f32_16x16x32_bf16 v[124:127], v[56:59], v[80:83], v[124:127]
    ds_read_b128 v[56:59], v35 offset:11264
    ds_read_b64_tr_b16 v[76:77], v28 offset:16896
    ds_read_b64_tr_b16 v[78:79], v29 offset:16896
    ds_read_b64_tr_b16 v[80:81], v28 offset:16928
    ds_read_b64_tr_b16 v[82:83], v29 offset:16928
    s_waitcnt lgkmcnt(10)
    v_mfma_f32_16x16x32_bf16 v[120:123], v[48:51], v[60:63], v[120:123]
    v_mfma_f32_16x16x32_bf16 v[124:127], v[48:51], v[64:67], v[124:127]
    ds_read_b128 v[48:51], v35 offset:12288
    ds_read_b64_tr_b16 v[60:61], v28 offset:18432
    ds_read_b64_tr_b16 v[62:63], v29 offset:18432
    ds_read_b64_tr_b16 v[64:65], v28 offset:18464
    ds_read_b64_tr_b16 v[66:67], v29 offset:18464
    s_waitcnt lgkmcnt(10)
    v_mfma_f32_16x16x32_bf16 v[120:123], v[52:55], v[68:71], v[120:123]
    v_mfma_f32_16x16x32_bf16 v[124:127], v[52:55], v[72:75], v[124:127]
    ds_read_b128 v[52:55], v35 offset:13312
    ds_read_b64_tr_b16 v[68:69], v28 offset:19968
    ds_read_b64_tr_b16 v[70:71], v29 offset:19968
    ds_read_b64_tr_b16 v[72:73], v28 offset:20000
    ds_read_b64_tr_b16 v[74:75], v29 offset:20000
    s_waitcnt lgkmcnt(10)
    v_mfma_f32_16x16x32_bf16 v[120:123], v[56:59], v[76:79], v[120:123]
    v_mfma_f32_16x16x32_bf16 v[124:127], v[56:59], v[80:83], v[124:127]
    ds_read_b128 v[56:59], v35 offset:14336
    ds_read_b64_tr_b16 v[76:77], v28 offset:21504
    ds_read_b64_tr_b16 v[78:79], v29 offset:21504
    ds_read_b64_tr_b16 v[80:81], v28 offset:21536
    ds_read_b64_tr_b16 v[82:83], v29 offset:21536
    s_waitcnt lgkmcnt(10)
    v_mfma_f32_16x16x32_bf16 v[120:123], v[48:51], v[60:63], v[120:123]
    v_mfma_f32_16x16x32_bf16 v[124:127], v[48:51], v[64:67], v[124:127]
    ds_read_b128 v[48:51], v35 offset:15360
    ds_read_b64_tr_b16 v[60:61], v28 offset:23040
    ds_read_b64_tr_b16 v[62:63], v29 offset:23040
    ds_read_b64_tr_b16 v[64:65], v28 offset:23072
    ds_read_b64_tr_b16 v[66:67], v29 offset:23072
    s_waitcnt lgkmcnt(10)
    v_mfma_f32_16x16x32_bf16 v[120:123], v[52:55], v[68:71], v[120:123]
    v_mfma_f32_16x16x32_bf16 v[124:127], v[52:55], v[72:75], v[124:127]
    ds_read_b128 v[52:55], v35 offset:16384
    ds_read_b64_tr_b16 v[68:69], v28 offset:24576
    ds_read_b64_tr_b16 v[70:71], v29 offset:24576
    ds_read_b64_tr_b16 v[72:73], v28 offset:24608
    ds_read_b64_tr_b16 v[74:75], v29 offset:24608
    s_waitcnt lgkmcnt(10)
    v_mfma_f32_16x16x32_bf16 v[120:123], v[56:59], v[76:79], v[120:123]
    v_mfma_f32_16x16x32_bf16 v[124:127], v[56:59], v[80:83], v[124:127]
    ds_read_b128 v[56:59], v35 offset:17408
    ds_read_b64_tr_b16 v[76:77], v28 offset:26112
    ds_read_b64_tr_b16 v[78:79], v29 offset:26112
    ds_read_b64_tr_b16 v[80:81], v28 offset:26144
    ds_read_b64_tr_b16 v[82:83], v29 offset:26144
    s_waitcnt lgkmcnt(10)
    v_mfma_f32_16x16x32_bf16 v[120:123], v[48:51], v[60:63], v[120:123]
    v_mfma_f32_16x16x32_bf16 v[124:127], v[48:51], v[64:67], v[124:127]
    s_waitcnt lgkmcnt(5)
    v_mfma_f32_16x16x32_bf16 v[120:123], v[52:55], v[68:71], v[120:123]
    v_mfma_f32_16x16x32_bf16 v[124:127], v[52:55], v[72:75], v[124:127]
    s_waitcnt lgkmcnt(0)
    v_mfma_f32_16x16x32_bf16 v[120:123], v[56:59], v[76:79], v[120:123]
    v_mfma_f32_16x16x32_bf16 v[124:127], v[56:59], v[80:83], v[124:127]
    v_mov_b32 v12, 163404
    s_mov_b32 s3, 524288
mega_lw_kvv:
    ds_read_b32 v13, v12
    s_waitcnt lgkmcnt(0)
    v_readfirstlane_b32 s39, v13
    s_nop 0
    s_cmp_ge_u32 s39, 2
    s_cbranch_scc1 mega_lwd_kvv
    s_sleep 1
    s_sub_u32 s3, s3, 1
    s_cbranch_scc0 mega_lw_kvv
mega_lwd_kvv:
    v_lshlrev_b32 v32, 2, v2
    v_add_u32 v32, 161344, v32
    v_lshlrev_b32 v33, 4, v3
    v_add_u32 v33, 161472, v33
    ds_read_b32 v6, v32
    ds_read_b32 v7, v32 offset:64
    ds_read_b128 v[16:19], v33
    ds_read_b128 v[20:23], v33 offset:64
    s_mul_i32 s38, s42, 1216
    s_mul_i32 s39, s43, 608
    s_add_u32 s38, s38, s39
    s_add_u32 s38, s38, s41
    s_add_u32 s38, s38, 4096
    s_movk_i32 s39, 304
    v_and_b32 v36, 1, v3
    v_mul_u32_u24 v37, s39, v36
    v_lshl_add_u32 v37, v2, 4, v37
    v_lshrrev_b32 v36, 1, v3
    s_movk_i32 s39, 160
    v_mad_u32_u24 v37, v36, s39, v37
    s_waitcnt lgkmcnt(0)
    v_fma_f32 v120, -v16, v6, v120
    v_fma_f32 v121, -v17, v6, v121
    v_fma_f32 v122, -v18, v6, v122
    v_fma_f32 v123, -v19, v6, v123
    v_mul_f32 v120, v20, v120
    v_mul_f32 v121, v21, v121
    v_mul_f32 v122, v22, v122
    v_mul_f32 v123, v23, v123
    v_fma_f32 v124, -v16, v7, v124
    v_fma_f32 v125, -v17, v7, v125
    v_fma_f32 v126, -v18, v7, v126
    v_fma_f32 v127, -v19, v7, v127
    v_mul_f32 v124, v20, v124
    v_mul_f32 v125, v21, v125
    v_mul_f32 v126, v22, v126
    v_mul_f32 v127, v23, v127
    v_cvt_pk_bf16_f32 v40, v120, v121
    v_cvt_pk_bf16_f32 v41, v122, v123
    v_cvt_pk_bf16_f32 v42, v124, v125
    v_cvt_pk_bf16_f32 v43, v126, v127
    v_mov_b32 v39, 0x3f803f80
    v_cmp_eq_u32 vcc, 8, v2
    s_nop 1
    v_cndmask_b32 v42, v42, v39, vcc
    v_cndmask_b32 v43, v43, v39, vcc
    s_nop 0
    v_permlane32_swap_b32 v40, v42
    v_permlane32_swap_b32 v41, v43
    s_mov_b32 exec_lo, 0xffffffff
    s_mov_b32 exec_hi, 0x1c001c0
    buffer_store_dwordx4 v[40:43], v37, s[16:19], s38 offen sc1
    s_mov_b64 exec, -1
    v_mov_b32 v45, 0
a_kv_pub:
    v_mov_b32 v12, 163432
    s_mov_b32 s3, 524288
mega_lw_non:
    ds_read_b32 v13, v12
    s_waitcnt lgkmcnt(0)
    v_readfirstlane_b32 s39, v13
    s_nop 0
    s_cmp_ge_u32 s39, 1
    s_cbranch_scc1 mega_lwd_non
    s_sleep 1
    s_sub_u32 s3, s3, 1
    s_cbranch_scc0 mega_lw_non
mega_lwd_non:
    v_mov_b32 v12, 163432
    ds_read_b64 v[14:15], v12
    s_waitcnt lgkmcnt(0)
    v_readfirstlane_b32 s66, v14
    v_readfirstlane_b32 s67, v15
    s_nop 0
    v_mov_b32 v44, s66
    v_mov_b32 v12, 0
    s_waitcnt vmcnt(0)
    s_mov_b32 exec_lo, 0x1
    s_mov_b32 exec_hi, 0x0
    buffer_store_dwordx2 v[44:45], v12, s[16:19], s49 offen sc1
    s_mov_b64 exec, -1
    s_waitcnt vmcnt(0)
    v_mov_b32 v12, 163404
    v_mov_b32 v13, 1
    s_mov_b32 exec_lo, 0x1
    s_mov_b32 exec_hi, 0x0
    ds_add_u32 v12, v13
    s_mov_b64 exec, -1
    s_branch a_s_done
a_sw:
    s_setprio 3
    s_cmp_eq_u32 s30, 7
    s_cbranch_scc1 a_s_7
    s_cmp_lt_u32 s29, 4
    s_cselect_b32 s20, s70, s72
    s_cselect_b32 s21, s71, s73
    s_mov_b32 s22, 20736
    s_mov_b32 s23, 0x00020000
    s_movk_i32 s40, 21846
    v_add_u32 v32, 0, v1
    v_mul_u32_u24 v33, s40, v32
    v_lshrrev_b32 v33, 16, v33
    v_mul_u32_u24 v34, 3, v33
    v_sub_u32 v34, v32, v34
    v_lshlrev_b32 v34, 4, v34
    v_min_u32 v34, 20, v34
    v_and_b32 v35, 8, v33
    v_lshrrev_b32 v35, 1, v35
    v_xor_b32 v35, v35, v33
    v_mad_u32_u24 v16, v35, 36, v34
    v_add_u32 v32, 64, v1
    v_mul_u32_u24 v33, s40, v32
    v_lshrrev_b32 v33, 16, v33
    v_mul_u32_u24 v34, 3, v33
    v_sub_u32 v34, v32, v34
    v_lshlrev_b32 v34, 4, v34
    v_min_u32 v34, 20, v34
    v_and_b32 v35, 8, v33
    v_lshrrev_b32 v35, 1, v35
    v_xor_b32 v35, v35, v33
    v_mad_u32_u24 v17, v35, 36, v34
    v_add_u32 v32, 128, v1
    v_mul_u32_u24 v33, s40, v32
    v_lshrrev_b32 v33, 16, v33
    v_mul_u32_u24 v34, 3, v33
    v_sub_u32 v34, v32, v34
    v_lshlrev_b32 v34, 4, v34
    v_min_u32 v34, 20, v34
    v_and_b32 v35, 8, v33
    v_lshrrev_b32 v35, 1, v35
    v_xor_b32 v35, v35, v33
    v_mad_u32_u24 v18, v35, 36, v34
    s_sub_u32 s34, s30, 4
    s_mul_i32 s34, s34, 3
    s_mul_i32 s43, s34, 3072
    s_lshr_b32 s35, s48, 1
    s_add_u32 s35, s35, s34
    s_sub_u32 s36, s35, 9
    s_min_u32 s35, s35, s36
    s_mul_i32 s35, s35, 2304
    s_add_u32 m0, s43, 0
    s_nop 0
    buffer_load_dwordx4 v16, s[20:23], s35 offen lds
    s_add_u32 m0, s43, 1024
    s_nop 0
    buffer_load_dwordx4 v17, s[20:23], s35 offen lds
    s_add_u32 m0, s43, 2048
    s_nop 0
    buffer_load_dwordx4 v18, s[20:23], s35 offen lds
    s_add_u32 s35, s35, 2304
    s_cmp_eq_u32 s35, 20736
    s_cselect_b32 s35, 0, s35
    s_add_u32 m0, s43, 3072
    s_nop 0
    buffer_load_dwordx4 v16, s[20:23], s35 offen lds
    s_add_u32 m0, s43, 4096
    s_nop 0
    buffer_load_dwordx4 v17, s[20:23], s35 offen lds
    s_add_u32 m0, s43, 5120
    s_nop 0
    buffer_load_dwordx4 v18, s[20:23], s35 offen lds
    s_add_u32 s35, s35, 2304
    s_cmp_eq_u32 s35, 20736
    s_cselect_b32 s35, 0, s35
    s_add_u32 m0, s43, 6144
    s_nop 0
    buffer_load_dwordx4 v16, s[20:23], s35 offen lds
    s_add_u32 m0, s43, 7168
    s_nop 0
    buffer_load_dwordx4 v17, s[20:23], s35 offen lds
    s_add_u32 m0, s43, 8192
    s_nop 0
    buffer_load_dwordx4 v18, s[20:23], s35 offen lds
    s_add_u32 s35, s35, 2304
    s_cmp_eq_u32 s35, 20736
    s_cselect_b32 s35, 0, s35
    s_barrier
    s_branch a_s_c
a_s_7:
    s_mul_i32 s34, s47, 1536
    v_min_u32 v12, 11, v1
    v_lshlrev_b32 v12, 7, v12
    v_add_u32 v12, s34, v12
    v_min_u32 v12, CODE_BYTES - 4, v12
    global_load_dword v18, v12, s[62:63]
    s_mov_b32 s56, s74
    s_mov_b32 s57, s75
    s_mov_b32 s58, 0x100
    s_mov_b32 s59, 0x00020000
    v_mov_b32 v10, 0
    v_min_u32 v12, 38, v1
    v_lshlrev_b32 v12, 2, v12
    v_add_u32 v12, 163328, v12
    v_mov_b32 v13, 0
    ds_write_b32 v12, v13
    v_lshlrev_b32 v12, 2, v1
    v_add_u32 v12, 161024, v12
    ds_write_b32 v12, v13
    ds_write_b32 v12, v13 offset:64
    s_waitcnt lgkmcnt(0)
    s_barrier
    s_mov_b32 s3, 65536
a_s_np:
    s_sleep 4
    buffer_load_dwordx2 v[14:15], v10, s[56:59], 0 offen sc1
    s_sleep 4
    buffer_load_dwordx2 v[16:17], v10, s[56:59], 0 offen sc1
    s_waitcnt vmcnt(1)
    v_readfirstlane_b32 s39, v14
    s_nop 0
    s_cmp_lg_u32 s39, 0
    s_cbranch_scc1 a_s_nd
    s_waitcnt vmcnt(0)
    v_mov_b32 v14, v16
    v_mov_b32 v15, v17
    v_readfirstlane_b32 s39, v16
    s_nop 0
    s_cmp_lg_u32 s39, 0
    s_cbranch_scc1 a_s_nd
    s_sub_u32 s3, s3, 1
    s_cbranch_scc0 a_s_np
a_s_nd:
    v_mov_b32 v12, 163432
    ds_write_b64 v12, v[14:15]
a_s_c:
    v_mov_b32 v36, 0x3f803f80
    v_mov_b32 v37, 0x3f803f80
    v_mov_b32 v38, 0x3f803f80
    v_mov_b32 v39, 0x3f803f80
    v_mov_b32 v120, 0
    v_mov_b32 v121, 0
    v_mov_b32 v122, 0
    v_mov_b32 v123, 0
    v_mov_b32 v124, 0
    v_mov_b32 v125, 0
    v_mov_b32 v126, 0
    v_mov_b32 v127, 0
    v_mov_b32 v128, 0
    v_mov_b32 v129, 0
    v_mov_b32 v130, 0
    v_mov_b32 v131, 0
    v_mov_b32 v132, 0
    v_mov_b32 v133, 0
    v_mov_b32 v134, 0
    v_mov_b32 v135, 0
    v_mov_b32 v136, 0
    v_mov_b32 v137, 0
    v_mov_b32 v138, 0
    v_mov_b32 v139, 0
    s_cmp_lg_u32 s30, 5
    s_cbranch_scc1 a_s_q
    v_lshrrev_b32 v32, 2, v2
    v_and_b32 v33, 1, v3
    v_lshlrev_b32 v33, 2, v33
    v_add_u32 v32, v32, v33
    v_lshl_add_u32 v32, v3, 3, v32
    v_xor_b32 v33, 4, v32
    s_movk_i32 s40, 48
    v_and_b32 v34, 3, v2
    v_lshlrev_b32 v34, 3, v34
    v_add_u32 v34, 0, v34
    v_mad_u32_u24 v28, v32, s40, v34
    v_mad_u32_u24 v29, v33, s40, v34
    s_waitcnt vmcnt(0)
    v_mov_b32 v12, 163416
    v_mov_b32 v13, 1
    s_mov_b32 exec_lo, 0x1
    s_mov_b32 exec_hi, 0x0
    ds_add_u32 v12, v13
    s_mov_b64 exec, -1
    v_mov_b32 v12, 163424
    v_mov_b32 v13, 1
    s_mov_b32 exec_lo, 0x1
    s_mov_b32 exec_hi, 0x0
    ds_add_u32 v12, v13
    s_mov_b64 exec, -1
    v_mov_b32 v12, 163424
    s_mov_b32 s3, 524288
mega_lw_wki:
    ds_read_b32 v13, v12
    s_waitcnt lgkmcnt(0)
    v_readfirstlane_b32 s39, v13
    s_nop 0
    s_cmp_ge_u32 s39, 3
    s_cbranch_scc1 mega_lwd_wki
    s_sleep 1
    s_sub_u32 s3, s3, 1
    s_cbranch_scc0 mega_lw_wki
mega_lwd_wki:
    ds_read_b64_tr_b16 v[48:49], v28 offset:0
    ds_read_b64_tr_b16 v[50:51], v29 offset:0
    ds_read_b64_tr_b16 v[52:53], v28 offset:32
    ds_read_b64_tr_b16 v[54:55], v29 offset:32
    ds_read_b64_tr_b16 v[56:57], v28 offset:1536
    ds_read_b64_tr_b16 v[58:59], v29 offset:1536
    ds_read_b64_tr_b16 v[60:61], v28 offset:1568
    ds_read_b64_tr_b16 v[62:63], v29 offset:1568
    ds_read_b64_tr_b16 v[64:65], v28 offset:3072
    ds_read_b64_tr_b16 v[66:67], v29 offset:3072
    ds_read_b64_tr_b16 v[68:69], v28 offset:3104
    ds_read_b64_tr_b16 v[70:71], v29 offset:3104
    s_waitcnt lgkmcnt(8)
    v_mfma_f32_16x16x32_bf16 v[120:123], v[36:39], v[48:51], v[120:123]
    v_mfma_f32_16x16x32_bf16 v[124:127], v[36:39], v[52:55], v[124:127]
    ds_read_b64_tr_b16 v[48:49], v28 offset:4608
    ds_read_b64_tr_b16 v[50:51], v29 offset:4608
    ds_read_b64_tr_b16 v[52:53], v28 offset:4640
    ds_read_b64_tr_b16 v[54:55], v29 offset:4640
    s_waitcnt lgkmcnt(8)
    v_mfma_f32_16x16x32_bf16 v[120:123], v[36:39], v[56:59], v[120:123]
    v_mfma_f32_16x16x32_bf16 v[124:127], v[36:39], v[60:63], v[124:127]
    ds_read_b64_tr_b16 v[56:57], v28 offset:6144
    ds_read_b64_tr_b16 v[58:59], v29 offset:6144
    ds_read_b64_tr_b16 v[60:61], v28 offset:6176
    ds_read_b64_tr_b16 v[62:63], v29 offset:6176
    s_waitcnt lgkmcnt(8)
    v_mfma_f32_16x16x32_bf16 v[120:123], v[36:39], v[64:67], v[120:123]
    v_mfma_f32_16x16x32_bf16 v[124:127], v[36:39], v[68:71], v[124:127]
    ds_read_b64_tr_b16 v[64:65], v28 offset:7680
    ds_read_b64_tr_b16 v[66:67], v29 offset:7680
    ds_read_b64_tr_b16 v[68:69], v28 offset:7712
    ds_read_b64_tr_b16 v[70:71], v29 offset:7712
    s_waitcnt lgkmcnt(8)
    v_mfma_f32_16x16x32_bf16 v[120:123], v[36:39], v[48:51], v[120:123]
    v_mfma_f32_16x16x32_bf16 v[124:127], v[36:39], v[52:55], v[124:127]
    ds_read_b64_tr_b16 v[48:49], v28 offset:9216
    ds_read_b64_tr_b16 v[50:51], v29 offset:9216
    ds_read_b64_tr_b16 v[52:53], v28 offset:9248
    ds_read_b64_tr_b16 v[54:55], v29 offset:9248
    s_waitcnt lgkmcnt(8)
    v_mfma_f32_16x16x32_bf16 v[120:123], v[36:39], v[56:59], v[120:123]
    v_mfma_f32_16x16x32_bf16 v[124:127], v[36:39], v[60:63], v[124:127]
    ds_read_b64_tr_b16 v[56:57], v28 offset:10752
    ds_read_b64_tr_b16 v[58:59], v29 offset:10752
    ds_read_b64_tr_b16 v[60:61], v28 offset:10784
    ds_read_b64_tr_b16 v[62:63], v29 offset:10784
    s_waitcnt lgkmcnt(8)
    v_mfma_f32_16x16x32_bf16 v[120:123], v[36:39], v[64:67], v[120:123]
    v_mfma_f32_16x16x32_bf16 v[124:127], v[36:39], v[68:71], v[124:127]
    ds_read_b64_tr_b16 v[64:65], v28 offset:12288
    ds_read_b64_tr_b16 v[66:67], v29 offset:12288
    ds_read_b64_tr_b16 v[68:69], v28 offset:12320
    ds_read_b64_tr_b16 v[70:71], v29 offset:12320
    s_waitcnt lgkmcnt(8)
    v_mfma_f32_16x16x32_bf16 v[120:123], v[36:39], v[48:51], v[120:123]
    v_mfma_f32_16x16x32_bf16 v[124:127], v[36:39], v[52:55], v[124:127]
    ds_read_b64_tr_b16 v[48:49], v28 offset:13824
    ds_read_b64_tr_b16 v[50:51], v29 offset:13824
    ds_read_b64_tr_b16 v[52:53], v28 offset:13856
    ds_read_b64_tr_b16 v[54:55], v29 offset:13856
    s_waitcnt lgkmcnt(8)
    v_mfma_f32_16x16x32_bf16 v[120:123], v[36:39], v[56:59], v[120:123]
    v_mfma_f32_16x16x32_bf16 v[124:127], v[36:39], v[60:63], v[124:127]
    ds_read_b64_tr_b16 v[56:57], v28 offset:15360
    ds_read_b64_tr_b16 v[58:59], v29 offset:15360
    ds_read_b64_tr_b16 v[60:61], v28 offset:15392
    ds_read_b64_tr_b16 v[62:63], v29 offset:15392
    s_waitcnt lgkmcnt(8)
    v_mfma_f32_16x16x32_bf16 v[120:123], v[36:39], v[64:67], v[120:123]
    v_mfma_f32_16x16x32_bf16 v[124:127], v[36:39], v[68:71], v[124:127]
    ds_read_b64_tr_b16 v[64:65], v28 offset:16896
    ds_read_b64_tr_b16 v[66:67], v29 offset:16896
    ds_read_b64_tr_b16 v[68:69], v28 offset:16928
    ds_read_b64_tr_b16 v[70:71], v29 offset:16928
    s_waitcnt lgkmcnt(8)
    v_mfma_f32_16x16x32_bf16 v[120:123], v[36:39], v[48:51], v[120:123]
    v_mfma_f32_16x16x32_bf16 v[124:127], v[36:39], v[52:55], v[124:127]
    ds_read_b64_tr_b16 v[48:49], v28 offset:18432
    ds_read_b64_tr_b16 v[50:51], v29 offset:18432
    ds_read_b64_tr_b16 v[52:53], v28 offset:18464
    ds_read_b64_tr_b16 v[54:55], v29 offset:18464
    s_waitcnt lgkmcnt(8)
    v_mfma_f32_16x16x32_bf16 v[120:123], v[36:39], v[56:59], v[120:123]
    v_mfma_f32_16x16x32_bf16 v[124:127], v[36:39], v[60:63], v[124:127]
    ds_read_b64_tr_b16 v[56:57], v28 offset:19968
    ds_read_b64_tr_b16 v[58:59], v29 offset:19968
    ds_read_b64_tr_b16 v[60:61], v28 offset:20000
    ds_read_b64_tr_b16 v[62:63], v29 offset:20000
    s_waitcnt lgkmcnt(8)
    v_mfma_f32_16x16x32_bf16 v[120:123], v[36:39], v[64:67], v[120:123]
    v_mfma_f32_16x16x32_bf16 v[124:127], v[36:39], v[68:71], v[124:127]
    ds_read_b64_tr_b16 v[64:65], v28 offset:21504
    ds_read_b64_tr_b16 v[66:67], v29 offset:21504
    ds_read_b64_tr_b16 v[68:69], v28 offset:21536
    ds_read_b64_tr_b16 v[70:71], v29 offset:21536
    s_waitcnt lgkmcnt(8)
    v_mfma_f32_16x16x32_bf16 v[120:123], v[36:39], v[48:51], v[120:123]
    v_mfma_f32_16x16x32_bf16 v[124:127], v[36:39], v[52:55], v[124:127]
    ds_read_b64_tr_b16 v[48:49], v28 offset:23040
    ds_read_b64_tr_b16 v[50:51], v29 offset:23040
    ds_read_b64_tr_b16 v[52:53], v28 offset:23072
    ds_read_b64_tr_b16 v[54:55], v29 offset:23072
    s_waitcnt lgkmcnt(8)
    v_mfma_f32_16x16x32_bf16 v[120:123], v[36:39], v[56:59], v[120:123]
    v_mfma_f32_16x16x32_bf16 v[124:127], v[36:39], v[60:63], v[124:127]
    ds_read_b64_tr_b16 v[56:57], v28 offset:24576
    ds_read_b64_tr_b16 v[58:59], v29 offset:24576
    ds_read_b64_tr_b16 v[60:61], v28 offset:24608
    ds_read_b64_tr_b16 v[62:63], v29 offset:24608
    s_waitcnt lgkmcnt(8)
    v_mfma_f32_16x16x32_bf16 v[120:123], v[36:39], v[64:67], v[120:123]
    v_mfma_f32_16x16x32_bf16 v[124:127], v[36:39], v[68:71], v[124:127]
    ds_read_b64_tr_b16 v[64:65], v28 offset:26112
    ds_read_b64_tr_b16 v[66:67], v29 offset:26112
    ds_read_b64_tr_b16 v[68:69], v28 offset:26144
    ds_read_b64_tr_b16 v[70:71], v29 offset:26144
    s_waitcnt lgkmcnt(8)
    v_mfma_f32_16x16x32_bf16 v[120:123], v[36:39], v[48:51], v[120:123]
    v_mfma_f32_16x16x32_bf16 v[124:127], v[36:39], v[52:55], v[124:127]
    s_waitcnt lgkmcnt(4)
    v_mfma_f32_16x16x32_bf16 v[120:123], v[36:39], v[56:59], v[120:123]
    v_mfma_f32_16x16x32_bf16 v[124:127], v[36:39], v[60:63], v[124:127]
    s_waitcnt lgkmcnt(0)
    v_mfma_f32_16x16x32_bf16 v[120:123], v[36:39], v[64:67], v[120:123]
    v_mfma_f32_16x16x32_bf16 v[124:127], v[36:39], v[68:71], v[124:127]
    v_lshlrev_b32 v32, 2, v2
    v_add_u32 v32, 161344, v32
    s_nop 4
    ds_write_b32 v32, v120
    ds_write_b32 v32, v124 offset:64
    s_waitcnt lgkmcnt(0)
    v_mov_b32 v12, 163404
    v_mov_b32 v13, 1
    s_mov_b32 exec_lo, 0x1
    s_mov_b32 exec_hi, 0x0
    ds_add_u32 v12, v13
    s_mov_b64 exec, -1
    s_branch a_s_done
a_s_q:
    s_cmp_eq_u32 s30, 7
    s_cbranch_scc1 a_s_nx
    s_waitcnt vmcnt(0)
    v_mov_b32 v12, 163416
    v_mov_b32 v13, 1
    s_mov_b32 exec_lo, 0x1
    s_mov_b32 exec_hi, 0x0
    ds_add_u32 v12, v13
    s_mov_b64 exec, -1
    v_mov_b32 v12, 163424
    v_mov_b32 v13, 1
    s_mov_b32 exec_lo, 0x1
    s_mov_b32 exec_hi, 0x0
    ds_add_u32 v12, v13
    s_mov_b64 exec, -1
a_s_nx:
a_s_done:
    s_waitcnt vmcnt(0)
a_done:
    s_setprio 3
    s_mov_b32 s52, 0
    v_and_b32 v2, 31, v1
    v_lshrrev_b32 v3, 5, v1
    s_lshr_b32 s35, s30, 2
    s_mul_i32 s35, s35, 4608
    s_add_u32 s35, s35, 151808
    s_movk_i32 s36, 2304
    v_lshrrev_b32 v8, 4, v2
    v_mul_u32_u24 v8, s36, v8
    v_and_b32 v9, 15, v2
    v_lshl_add_u32 v8, v9, 4, v8
    v_add_u32 v8, s35, v8
    v_lshl_add_u32 v9, v3, 8, v8
    s_and_b32 s37, s30, 3
    s_mul_i32 s37, s37, 18
    s_add_u32 s38, s37, 0
    s_lshr_b32 s39, s38, 3
    s_lshl_b32 s39, s39, 8
    s_and_b32 s38, s38, 7
    s_lshl_b32 s38, s38, 1
    s_add_u32 s38, s38, s39
    v_add_u32 v88, s38, v9
    v_add_u32 v96, s38, v8
    s_add_u32 s38, s37, 2
    s_lshr_b32 s39, s38, 3
    s_lshl_b32 s39, s39, 8
    s_and_b32 s38, s38, 7
    s_lshl_b32 s38, s38, 1
    s_add_u32 s38, s38, s39
    v_add_u32 v89, s38, v9
    s_add_u32 s38, s37, 4
    s_lshr_b32 s39, s38, 3
    s_lshl_b32 s39, s39, 8
    s_and_b32 s38, s38, 7
    s_lshl_b32 s38, s38, 1
    s_add_u32 s38, s38, s39
    v_add_u32 v90, s38, v9
    s_add_u32 s38, s37, 6
    s_lshr_b32 s39, s38, 3
    s_lshl_b32 s39, s39, 8
    s_and_b32 s38, s38, 7
    s_lshl_b32 s38, s38, 1
    s_add_u32 s38, s38, s39
    v_add_u32 v91, s38, v9
    v_mov_b32 v98, 163412
    v_mov_b32 v12, v11
    v_cmp_eq_u32 vcc, 28, v2
    s_nop 1
    v_cndmask_b32 v13, v2, 18, vcc
    v_cmp_lt_u32 vcc, 18, v13
    v_mov_b32 v14, 0x10000
    s_nop 0
    v_cndmask_b32 v13, v13, v14, vcc
    s_movk_i32 s40, 304
    v_mul_u32_u24 v14, s40, v3
    v_lshl_add_u32 v13, v13, 4, v14
    v_add_u32 v13, 4096, v13
    v_min_u32 v14, 32, v1
    v_lshlrev_b32 v14, 4, v14
    v_add_u32 v14, 8960, v14
    v_cmp_eq_u32 s[44:45], 1, v3
    s_lshr_b32 s35, s30, 2
    s_lshl_b32 s35, s35, 2
    s_add_u32 s35, s35, 163456
    v_mov_b32 v48, 0
    v_mov_b32 v49, 0
    v_mov_b32 v50, 0
    v_mov_b32 v51, 0
    v_mov_b32 v52, 0
    v_mov_b32 v53, 0
    v_mov_b32 v54, 0
    v_mov_b32 v55, 0
    v_mov_b32 v56, 0
    v_mov_b32 v57, 0
    v_mov_b32 v58, 0
    v_mov_b32 v59, 0
    v_mov_b32 v60, 0
    v_mov_b32 v61, 0
    v_mov_b32 v62, 0
    v_mov_b32 v63, 0
    v_mov_b32 v64, 0
    v_mov_b32 v65, 0
    v_mov_b32 v66, 0
    v_mov_b32 v67, 0
    v_mov_b32 v68, 0
    v_mov_b32 v69, 0
    v_mov_b32 v70, 0
    v_mov_b32 v71, 0
    v_mov_b32 v80, 0
    v_mov_b32 v81, 0
    v_mov_b32 v82, 0
    v_mov_b32 v83, 0
    v_mov_b32 v4, v12
    v_mov_b32 v5, v13
    v_mov_b32 v6, v14
    s_mov_b32 s32, 0
    s_mov_b32 s31, 2
    v_mov_b32 v102, 163468
    s_mov_b32 s3, 524288
mega_lw_im0:
    ds_read_b32 v103, v102
    s_waitcnt lgkmcnt(0)
    v_readfirstlane_b32 s39, v103
    s_nop 0
    s_cmp_ge_u32 s39, 4
    s_cbranch_scc1 mega_lwd_im0
    s_sleep 1
    s_sub_u32 s3, s3, 1
    s_cbranch_scc0 mega_lw_im0
mega_lwd_im0:
    ds_read_b32 v98, v98
    v_mov_b32 v102, 163432
    ds_read_b64 v[104:105], v102
    ds_read_b128 v[72:75], v4
    ds_read_b128 v[84:87], v6
    ds_read_b128 v[76:79], v5
    v_mov_b32 v102, s35
    s_mov_b32 s3, 524288
mega_lw_qrd:
    ds_read_b32 v103, v102
    s_waitcnt lgkmcnt(0)
    v_readfirstlane_b32 s39, v103
    s_nop 0
    s_cmp_ge_u32 s39, 2
    s_cbranch_scc1 mega_lwd_qrd
    s_sleep 1
    s_sub_u32 s3, s3, 1
    s_cbranch_scc0 mega_lw_qrd
mega_lwd_qrd:
    ds_read_b32 v88, v88
    ds_read_b32 v89, v89
    ds_read_b32 v90, v90
    ds_read_b32 v91, v91
    ds_read_b32 v96, v96 offset:512
    v_readfirstlane_b32 s66, v104
    v_readfirstlane_b32 s67, v105
    v_mul_f32 v98, 0x3f852bd4, v98
    v_mov_b32 v97, 0
    s_waitcnt lgkmcnt(0)
    v_cndmask_b32 v96, v96, 0, s[44:45]
    v_dot2c_f32_bf16 v97, v88, v88
    v_dot2c_f32_bf16 v97, v89, v89
    v_dot2c_f32_bf16 v97, v90, v90
    v_dot2c_f32_bf16 v97, v91, v91
    v_dot2c_f32_bf16 v97, v96, v96
    v_mfma_f32_32x32x16_bf16 v[16:31], v[72:75], v[88:91], 0
    ds_read_b128 v[72:75], v4 offset:1024
    s_nop 0
    v_mov_b32 v100, v97
    s_nop 1
    v_permlane32_swap_b32 v97, v100
    v_add_f32 v97, v97, v100
    v_mul_f32 v97, v97, v98
    v_sqrt_f32 v97, v97
    s_nop 0
    v_xor_b32 v98, 0x80000000, v97
    v_and_b32 v99, 0xffff0000, v98
    v_sub_f32 v98, v98, v99
    v_and_b32 v100, 0xffff0000, v98
    v_sub_f32 v98, v98, v100
    v_lshrrev_b32 v99, 16, v99
    v_or_b32 v99, v99, v100
    v_lshrrev_b32 v98, 16, v98
    v_cndmask_b32 v92, v96, v99, s[44:45]
    v_cndmask_b32 v93, 0, v98, s[44:45]
    v_cndmask_b32 v94, 0, v99, s[44:45]
    v_cndmask_b32 v95, v96, v98, s[44:45]
    s_setprio 2
    s_branch attn_go
attn_setm:
    v_xor_b32 v98, 0x80000000, v97
    v_and_b32 v99, 0xffff0000, v98
    v_sub_f32 v98, v98, v99
    v_and_b32 v100, 0xffff0000, v98
    v_sub_f32 v98, v98, v100
    v_lshrrev_b32 v99, 16, v99
    v_or_b32 v99, v99, v100
    v_lshrrev_b32 v98, 16, v98
    v_cndmask_b32 v92, v96, v99, s[44:45]
    v_cndmask_b32 v93, 0, v98, s[44:45]
    v_cndmask_b32 v94, 0, v99, s[44:45]
    v_cndmask_b32 v95, v96, v98, s[44:45]
    v_mov_b32 v4, v12
    v_mov_b32 v5, v13
    v_mov_b32 v6, v14
    s_cmp_eq_u32 s32, 10
    s_cbranch_scc1 attn_maxpass
    v_mov_b32 v48, 0
    v_mov_b32 v49, 0
    v_mov_b32 v50, 0
    v_mov_b32 v51, 0
    v_mov_b32 v52, 0
    v_mov_b32 v53, 0
    v_mov_b32 v54, 0
    v_mov_b32 v55, 0
    v_mov_b32 v56, 0
    v_mov_b32 v57, 0
    v_mov_b32 v58, 0
    v_mov_b32 v59, 0
    v_mov_b32 v60, 0
    v_mov_b32 v61, 0
    v_mov_b32 v62, 0
    v_mov_b32 v63, 0
    v_mov_b32 v64, 0
    v_mov_b32 v65, 0
    v_mov_b32 v66, 0
    v_mov_b32 v67, 0
    v_mov_b32 v68, 0
    v_mov_b32 v69, 0
    v_mov_b32 v70, 0
    v_mov_b32 v71, 0
    v_mov_b32 v80, 0
    v_mov_b32 v81, 0
    v_mov_b32 v82, 0
    v_mov_b32 v83, 0
    s_mov_b32 s31, 16
    ds_read_b128 v[72:75], v4
    ds_read_b128 v[84:87], v6
    ds_read_b128 v[76:79], v5
    s_waitcnt lgkmcnt(0)
    v_mfma_f32_32x32x16_bf16 v[16:31], v[72:75], v[88:91], 0
    ds_read_b128 v[72:75], v4 offset:1024
attn_go:
    v_mfma_f32_32x32x8_bf16 v[16:31], v[84:85], v[92:93], v[16:31]
    s_waitcnt lgkmcnt(0)
    s_nop 7
    s_nop 3
    .p2align 6
attn_loop:
    s_waitcnt lgkmcnt(2)
    v_mfma_f32_32x32x16_bf16 v[32:47], v[72:75], v[88:91], 0
    ds_read_b128 v[72:75], v4 offset:2048
    v_exp_f32 v16, v16
    v_exp_f32 v17, v17
    v_exp_f32 v18, v18
    s_waitcnt lgkmcnt(2)
    v_mfma_f32_32x32x16_bf16 v[48:63], v[80:83], v[68:71], v[48:63]
    ds_read_b128 v[80:83], v5 offset:608
    v_exp_f32 v19, v19
    v_exp_f32 v20, v20
    v_exp_f32 v21, v21
    v_mfma_f32_32x32x8_bf16 v[32:47], v[84:85], v[94:95], v[32:47]
    v_exp_f32 v22, v22
    v_exp_f32 v23, v23
    v_exp_f32 v24, v24
    v_cvt_pk_bf16_f32 v64, v16, v17
    v_cvt_pk_bf16_f32 v65, v18, v19
    v_cvt_pk_bf16_f32 v66, v20, v21
    v_cvt_pk_bf16_f32 v67, v22, v23
    v_exp_f32 v25, v25
    v_exp_f32 v26, v26
    v_exp_f32 v27, v27
    s_waitcnt lgkmcnt(2)
    v_mfma_f32_32x32x16_bf16 v[48:63], v[76:79], v[64:67], v[48:63]
    ds_read_b128 v[76:79], v5 offset:1216
    v_exp_f32 v28, v28
    v_exp_f32 v29, v29
    v_exp_f32 v30, v30
    v_exp_f32 v31, v31
    v_cvt_pk_bf16_f32 v68, v24, v25
    v_cvt_pk_bf16_f32 v69, v26, v27
    v_cvt_pk_bf16_f32 v70, v28, v29
    v_cvt_pk_bf16_f32 v71, v30, v31
    s_waitcnt lgkmcnt(2)
    v_mfma_f32_32x32x16_bf16 v[16:31], v[72:75], v[88:91], 0
    ds_read_b128 v[72:75], v4 offset:3072
    v_exp_f32 v32, v32
    v_exp_f32 v33, v33
    v_exp_f32 v34, v34
    s_waitcnt lgkmcnt(2)
    v_mfma_f32_32x32x16_bf16 v[48:63], v[80:83], v[68:71], v[48:63]
    ds_read_b128 v[80:83], v5 offset:1824
    v_exp_f32 v35, v35
    v_exp_f32 v36, v36
    v_exp_f32 v37, v37
    v_mfma_f32_32x32x8_bf16 v[16:31], v[86:87], v[92:93], v[16:31]
    v_exp_f32 v38, v38
    v_exp_f32 v39, v39
    v_exp_f32 v40, v40
    v_cvt_pk_bf16_f32 v64, v32, v33
    v_cvt_pk_bf16_f32 v65, v34, v35
    v_cvt_pk_bf16_f32 v66, v36, v37
    v_cvt_pk_bf16_f32 v67, v38, v39
    v_exp_f32 v41, v41
    v_exp_f32 v42, v42
    v_exp_f32 v43, v43
    s_waitcnt lgkmcnt(2)
    v_mfma_f32_32x32x16_bf16 v[48:63], v[76:79], v[64:67], v[48:63]
    ds_read_b128 v[76:79], v5 offset:2432
    v_exp_f32 v44, v44
    v_exp_f32 v45, v45
    v_exp_f32 v46, v46
    v_exp_f32 v47, v47
    v_cvt_pk_bf16_f32 v68, v40, v41
    v_cvt_pk_bf16_f32 v69, v42, v43
    v_cvt_pk_bf16_f32 v70, v44, v45
    v_cvt_pk_bf16_f32 v71, v46, v47
    s_waitcnt lgkmcnt(2)
    v_mfma_f32_32x32x16_bf16 v[32:47], v[72:75], v[88:91], 0
    ds_read_b128 v[72:75], v4 offset:9488
    v_exp_f32 v16, v16
    v_exp_f32 v17, v17
    v_exp_f32 v18, v18
    s_waitcnt lgkmcnt(2)
    v_mfma_f32_32x32x16_bf16 v[48:63], v[80:83], v[68:71], v[48:63]
    ds_read_b128 v[80:83], v5 offset:3040
    v_exp_f32 v19, v19
    v_exp_f32 v20, v20
    v_exp_f32 v21, v21
    v_mfma_f32_32x32x8_bf16 v[32:47], v[86:87], v[94:95], v[32:47]
    ds_read_b128 v[84:87], v6 offset:9488
    v_exp_f32 v22, v22
    v_exp_f32 v23, v23
    v_exp_f32 v24, v24
    v_cvt_pk_bf16_f32 v64, v16, v17
    v_cvt_pk_bf16_f32 v65, v18, v19
    v_cvt_pk_bf16_f32 v66, v20, v21
    v_cvt_pk_bf16_f32 v67, v22, v23
    v_exp_f32 v25, v25
    v_exp_f32 v26, v26
    v_exp_f32 v27, v27
    s_waitcnt lgkmcnt(2)
    v_mfma_f32_32x32x16_bf16 v[48:63], v[76:79], v[64:67], v[48:63]
    ds_read_b128 v[76:79], v5 offset:3648
    v_exp_f32 v28, v28
    v_exp_f32 v29, v29
    v_exp_f32 v30, v30
    v_exp_f32 v31, v31
    v_cvt_pk_bf16_f32 v68, v24, v25
    v_cvt_pk_bf16_f32 v69, v26, v27
    v_cvt_pk_bf16_f32 v70, v28, v29
    v_cvt_pk_bf16_f32 v71, v30, v31
    s_waitcnt lgkmcnt(2)
    v_mfma_f32_32x32x16_bf16 v[16:31], v[72:75], v[88:91], 0
    ds_read_b128 v[72:75], v4 offset:10512
    v_exp_f32 v32, v32
    v_exp_f32 v33, v33
    v_exp_f32 v34, v34
    s_waitcnt lgkmcnt(2)
    v_mfma_f32_32x32x16_bf16 v[48:63], v[80:83], v[68:71], v[48:63]
    ds_read_b128 v[80:83], v5 offset:4256
    v_exp_f32 v35, v35
    v_exp_f32 v36, v36
    v_exp_f32 v37, v37
    v_mfma_f32_32x32x8_bf16 v[16:31], v[84:85], v[92:93], v[16:31]
    v_exp_f32 v38, v38
    v_exp_f32 v39, v39
    v_exp_f32 v40, v40
    v_cvt_pk_bf16_f32 v64, v32, v33
    v_cvt_pk_bf16_f32 v65, v34, v35
    v_cvt_pk_bf16_f32 v66, v36, v37
    v_cvt_pk_bf16_f32 v67, v38, v39
    v_exp_f32 v41, v41
    v_exp_f32 v42, v42
    v_exp_f32 v43, v43
    s_waitcnt lgkmcnt(2)
    v_mfma_f32_32x32x16_bf16 v[48:63], v[76:79], v[64:67], v[48:63]
    ds_read_b128 v[76:79], v5 offset:9488
    v_exp_f32 v44, v44
    v_exp_f32 v45, v45
    v_exp_f32 v46, v46
    v_exp_f32 v47, v47
    v_add_u32 v4, 9488, v4
    v_add_u32 v5, 9488, v5
    v_add_u32 v6, 9488, v6
    s_sub_u32 s31, s31, 1
    s_cmp_lg_u32 s31, 0
    v_cvt_pk_bf16_f32 v68, v40, v41
    v_cvt_pk_bf16_f32 v69, v42, v43
    v_cvt_pk_bf16_f32 v70, v44, v45
    v_cvt_pk_bf16_f32 v71, v46, v47
    s_cbranch_scc1 attn_loop
    s_cmp_ge_u32 s32, 4
    s_cbranch_scc1 attn_tail
    s_add_u32 s32, s32, 1
    s_cmp_eq_u32 s32, 2
    s_cbranch_scc1 attn_ph2
    s_cmp_eq_u32 s32, 3
    s_cbranch_scc1 attn_ph3
    s_cmp_eq_u32 s32, 4
    s_cbranch_scc1 attn_ph4
    v_mov_b32 v102, 163444
    s_mov_b32 s3, 524288
mega_lw_img:
    ds_read_b32 v103, v102
    s_waitcnt lgkmcnt(0)
    v_readfirstlane_b32 s39, v103
    s_nop 0
    s_cmp_ge_u32 s39, 4
    s_cbranch_scc1 mega_lwd_img
    s_sleep 1
    s_sub_u32 s3, s3, 1
    s_cbranch_scc0 mega_lw_img
mega_lwd_img:
    s_mov_b32 s31, 9
    s_branch attn_loop
attn_ph2:
    s_setprio 1
    s_mov_b32 s31, 2
    v_cndmask_b32 v101, v58, v60, s[44:45]
    v_cmp_le_f32 vcc, 0x2b800000, v101
    s_nop 0
    s_cmp_eq_u64 vcc, -1
    s_cselect_b32 s34, 1, 0x101
    v_mov_b32 v102, 163428
    v_mov_b32 v103, s34
    s_mov_b32 exec_lo, 0x1
    s_mov_b32 exec_hi, 0x0
    ds_add_u32 v102, v103
    s_mov_b64 exec, -1
    s_branch attn_loop
attn_ph3:
    s_setprio 1
    s_mov_b32 s31, 2
    s_branch attn_loop
attn_ph4:
    s_setprio 0
    s_mov_b32 s31, 1
    v_mov_b32 v102, 163328
    ds_read_b32 v102, v102
    s_waitcnt lgkmcnt(0)
    v_readfirstlane_b32 s52, v102
    s_nop 0
    s_cmp_eq_u32 s52, 0
    s_cbranch_scc1 attn_loop
    s_mul_i32 s34, s30, 110592
    s_mul_i32 s35, s46, 1327104
    s_add_u32 s34, s34, s35
    s_add_u32 s34, s34, 7602176
    s_add_u32 s20, s12, s34
    s_addc_u32 s21, s13, 0
    s_mov_b32 s22, 110592
    s_mov_b32 s23, 0x00020000
    s_mov_b32 s53, 0
    buffer_load_dwordx4 v[108:111], v11, s[20:23], s53 offen offset:0 sc1
    buffer_load_dwordx4 v[112:115], v11, s[20:23], s53 offen offset:1024 sc1
    buffer_load_dwordx4 v[116:119], v11, s[20:23], s53 offen offset:2048 sc1
    s_add_u32 s53, s53, 3072
    buffer_load_dwordx4 v[120:123], v11, s[20:23], s53 offen offset:0 sc1
    buffer_load_dwordx4 v[124:127], v11, s[20:23], s53 offen offset:1024 sc1
    buffer_load_dwordx4 v[128:131], v11, s[20:23], s53 offen offset:2048 sc1
    s_add_u32 s53, s53, 3072
    buffer_load_dwordx4 v[132:135], v11, s[20:23], s53 offen offset:0 sc1
    buffer_load_dwordx4 v[136:139], v11, s[20:23], s53 offen offset:1024 sc1
    buffer_load_dwordx4 v[140:143], v11, s[20:23], s53 offen offset:2048 sc1
    s_add_u32 s53, s53, 3072
    buffer_load_dwordx4 v[144:147], v11, s[20:23], s53 offen offset:0 sc1
    buffer_load_dwordx4 v[148:151], v11, s[20:23], s53 offen offset:1024 sc1
    buffer_load_dwordx4 v[152:155], v11, s[20:23], s53 offen offset:2048 sc1
    s_add_u32 s53, s53, 3072
    buffer_load_dwordx4 v[156:159], v11, s[20:23], s53 offen offset:0 sc1
    buffer_load_dwordx4 v[160:163], v11, s[20:23], s53 offen offset:1024 sc1
    buffer_load_dwordx4 v[164:167], v11, s[20:23], s53 offen offset:2048 sc1
    s_add_u32 s53, s53, 3072
    s_branch attn_loop
attn_maxpass:
    v_mov_b32 v97, 0xff800000
    s_mov_b32 s31, 16
attn_maxloop:
    ds_read_b128 v[84:87], v6
    ds_read_b128 v[72:75], v4 offset:0
    s_waitcnt lgkmcnt(0)
    v_mfma_f32_32x32x16_bf16 v[16:31], v[72:75], v[88:91], 0
    v_mfma_f32_32x32x8_bf16 v[16:31], v[84:85], v[92:93], v[16:31]
    s_nop 11
    v_max3_f32 v97, v16, v17, v97
    v_max3_f32 v97, v18, v19, v97
    v_max3_f32 v97, v20, v21, v97
    v_max3_f32 v97, v22, v23, v97
    v_max3_f32 v97, v24, v25, v97
    v_max3_f32 v97, v26, v27, v97
    v_max3_f32 v97, v28, v29, v97
    v_max3_f32 v97, v30, v31, v97
    ds_read_b128 v[72:75], v4 offset:1024
    s_waitcnt lgkmcnt(0)
    v_mfma_f32_32x32x16_bf16 v[16:31], v[72:75], v[88:91], 0
    v_mfma_f32_32x32x8_bf16 v[16:31], v[84:85], v[94:95], v[16:31]
    s_nop 11
    v_max3_f32 v97, v16, v17, v97
    v_max3_f32 v97, v18, v19, v97
    v_max3_f32 v97, v20, v21, v97
    v_max3_f32 v97, v22, v23, v97
    v_max3_f32 v97, v24, v25, v97
    v_max3_f32 v97, v26, v27, v97
    v_max3_f32 v97, v28, v29, v97
    v_max3_f32 v97, v30, v31, v97
    ds_read_b128 v[72:75], v4 offset:2048
    s_waitcnt lgkmcnt(0)
    v_mfma_f32_32x32x16_bf16 v[16:31], v[72:75], v[88:91], 0
    v_mfma_f32_32x32x8_bf16 v[16:31], v[86:87], v[92:93], v[16:31]
    s_nop 11
    v_max3_f32 v97, v16, v17, v97
    v_max3_f32 v97, v18, v19, v97
    v_max3_f32 v97, v20, v21, v97
    v_max3_f32 v97, v22, v23, v97
    v_max3_f32 v97, v24, v25, v97
    v_max3_f32 v97, v26, v27, v97
    v_max3_f32 v97, v28, v29, v97
    v_max3_f32 v97, v30, v31, v97
    ds_read_b128 v[72:75], v4 offset:3072
    s_waitcnt lgkmcnt(0)
    v_mfma_f32_32x32x16_bf16 v[16:31], v[72:75], v[88:91], 0
    v_mfma_f32_32x32x8_bf16 v[16:31], v[86:87], v[94:95], v[16:31]
    s_nop 11
    v_max3_f32 v97, v16, v17, v97
    v_max3_f32 v97, v18, v19, v97
    v_max3_f32 v97, v20, v21, v97
    v_max3_f32 v97, v22, v23, v97
    v_max3_f32 v97, v24, v25, v97
    v_max3_f32 v97, v26, v27, v97
    v_max3_f32 v97, v28, v29, v97
    v_max3_f32 v97, v30, v31, v97
    v_add_u32 v4, 9488, v4
    v_add_u32 v6, 9488, v6
    s_sub_u32 s31, s31, 1
    s_cmp_lg_u32 s31, 0
    s_cbranch_scc1 attn_maxloop
    v_mov_b32 v98, v97
    s_nop 1
    v_permlane32_swap_b32 v97, v98
    v_max_f32 v97, v97, v98
    s_mov_b32 s32, 11
    s_branch attn_setm
attn_tail:
    s_waitcnt lgkmcnt(0)
    v_mfma_f32_32x32x16_bf16 v[48:63], v[80:83], v[68:71], v[48:63]
    s_and_b32 s34, s30, 3
    s_mul_i32 s34, s34, 18
    s_lshr_b32 s35, s30, 2
    s_mul_i32 s35, s35, 4608
    s_add_u32 s35, s35, 151808
    s_movk_i32 s36, 2304
    v_lshrrev_b32 v105, 4, v2
    v_mul_u32_u24 v105, s36, v105
    v_and_b32 v104, 15, v2
    v_lshl_add_u32 v105, v104, 4, v105
    v_add_u32 v105, s35, v105
    v_lshl_add_u32 v102, v3, 2, s34
    v_add_u32 v103, 2, v102
    v_lshrrev_b32 v104, 3, v102
    v_and_b32 v102, 7, v102
    v_lshl_add_u32 v102, v102, 1, v105
    v_lshl_add_u32 v102, v104, 8, v102
    v_lshrrev_b32 v104, 3, v103
    v_and_b32 v103, 7, v103
    v_lshl_add_u32 v103, v103, 1, v105
    v_lshl_add_u32 v103, v104, 8, v103
    v_cndmask_b32 v101, v58, v60, s[44:45]
    v_cmp_le_f32 vcc, 0x2b800000, v101
    s_cmp_eq_u32 s32, 11
    s_cbranch_scc1 attn_fin
    s_cmp_eq_u64 vcc, -1
    s_cbranch_scc1 attn_fin
    s_mov_b32 s32, 10
    v_mov_b32 v97, 0
    s_branch attn_setm
attn_fin:
    v_rcp_f32 v101, v101
    s_nop 0
    v_mul_f32 v48, v101, v48
    v_mul_f32 v49, v101, v49
    v_mul_f32 v50, v101, v50
    v_mul_f32 v51, v101, v51
    v_mul_f32 v52, v101, v52
    v_mul_f32 v53, v101, v53
    v_mul_f32 v54, v101, v54
    v_mul_f32 v55, v101, v55
    v_mul_f32 v56, v101, v56
    v_mul_f32 v57, v101, v57
    v_cvt_pk_bf16_f32 v64, v48, v49
    v_cvt_pk_bf16_f32 v65, v50, v51
    v_cvt_pk_bf16_f32 v66, v52, v53
    v_cvt_pk_bf16_f32 v67, v54, v55
    v_cvt_pk_bf16_f32 v68, v56, v57
    ds_write_b32 v102, v64
    ds_write_b32 v103, v65
    ds_write_b32 v102, v66 offset:256
    ds_write_b32 v103, v67 offset:256
    s_mov_b32 exec_lo, 0xffffffff
    s_mov_b32 exec_hi, 0x0
    ds_write_b32 v102, v68 offset:512
    s_mov_b64 exec, -1
    s_waitcnt lgkmcnt(0)
    s_barrier
    s_and_b32 s34, s30, 3
    s_lshr_b32 s35, s30, 2
    s_mul_i32 s36, s34, 2304
    s_mul_i32 s37, s35, 768
    s_add_u32 s36, s36, s37
    s_add_u32 s36, s36, 151808
    v_add_u32 v12, s36, v11
    ds_read_b128 v[4:7], v12
    s_lshl_b32 s36, s28, 2
    s_add_u32 s36, s36, s34
    s_mul_i32 s38, s36, 18432
    s_mul_i32 s39, s29, 2304
    s_add_u32 s38, s38, s39
    s_add_u32 s38, s38, s37
    s_add_u32 s38, s38, 2359296
    s_mul_i32 s39, s28, 0
    s_add_u32 s38, s38, s39
    s_lshl_b32 s36, s28, 7
    s_lshl_b32 s39, s29, 3
    s_add_u32 s36, s36, s39
    s_add_u32 s36, s36, 7077888
    s_waitcnt lgkmcnt(0)
    s_mov_b32 exec_lo, 0xffffffff
    s_mov_b32 exec_hi, 0xffff
    buffer_store_dwordx4 v[4:7], v11, s[16:19], s38 offen sc1
    s_mov_b64 exec, -1
    s_waitcnt vmcnt(0)
    v_mov_b32 v12, 163348
    v_mov_b32 v13, 1
    s_mov_b32 exec_lo, 0x1
    s_mov_b32 exec_hi, 0x0
    ds_add_rtn_u32 v14, v12, v13
    s_mov_b64 exec, -1
    s_waitcnt lgkmcnt(0)
    v_readfirstlane_b32 s3, v14
    s_nop 0
    s_cmp_lg_u32 s3, 11
    s_cbranch_scc1 mega_arr_oa
    v_mov_b32 v12, 0
    v_mov_b32 v14, s66
    v_mov_b32 v15, s67
    s_mov_b32 exec_lo, 0x1
    s_mov_b32 exec_hi, 0x0
    buffer_store_dwordx2 v[14:15], v12, s[16:19], s36 offen sc1
    s_mov_b64 exec, -1
mega_arr_oa:
    s_cmp_lg_u32 s52, 0
    s_cbranch_scc1 mega_ringed
    s_mul_i32 s34, s30, 110592
    s_mul_i32 s35, s46, 1327104
    s_add_u32 s34, s34, s35
    s_add_u32 s34, s34, 7602176
    s_add_u32 s20, s12, s34
    s_addc_u32 s21, s13, 0
    s_mov_b32 s22, 110592
    s_mov_b32 s23, 0x00020000
    s_mov_b32 s53, 0
    buffer_load_dwordx4 v[108:111], v11, s[20:23], s53 offen offset:0 sc1
    buffer_load_dwordx4 v[112:115], v11, s[20:23], s53 offen offset:1024 sc1
    buffer_load_dwordx4 v[116:119], v11, s[20:23], s53 offen offset:2048 sc1
    s_add_u32 s53, s53, 3072
    buffer_load_dwordx4 v[120:123], v11, s[20:23], s53 offen offset:0 sc1
    buffer_load_dwordx4 v[124:127], v11, s[20:23], s53 offen offset:1024 sc1
    buffer_load_dwordx4 v[128:131], v11, s[20:23], s53 offen offset:2048 sc1
    s_add_u32 s53, s53, 3072
    buffer_load_dwordx4 v[132:135], v11, s[20:23], s53 offen offset:0 sc1
    buffer_load_dwordx4 v[136:139], v11, s[20:23], s53 offen offset:1024 sc1
    buffer_load_dwordx4 v[140:143], v11, s[20:23], s53 offen offset:2048 sc1
    s_add_u32 s53, s53, 3072
    buffer_load_dwordx4 v[144:147], v11, s[20:23], s53 offen offset:0 sc1
    buffer_load_dwordx4 v[148:151], v11, s[20:23], s53 offen offset:1024 sc1
    buffer_load_dwordx4 v[152:155], v11, s[20:23], s53 offen offset:2048 sc1
    s_add_u32 s53, s53, 3072
    buffer_load_dwordx4 v[156:159], v11, s[20:23], s53 offen offset:0 sc1
    buffer_load_dwordx4 v[160:163], v11, s[20:23], s53 offen offset:1024 sc1
    buffer_load_dwordx4 v[164:167], v11, s[20:23], s53 offen offset:2048 sc1
    s_add_u32 s53, s53, 3072
mega_ringed:
    v_mov_b32 v12, 163440
    s_mov_b32 s3, 524288
mega_lw_ord2:
    ds_read_b32 v13, v12
    s_waitcnt lgkmcnt(0)
    v_readfirstlane_b32 s39, v13
    s_nop 0
    s_cmp_ge_u32 s39, 4
    s_cbranch_scc1 mega_lwd_ord2
    s_sleep 4
    s_sub_u32 s3, s3, 1
    s_cbranch_scc0 mega_lw_ord2
mega_lwd_ord2:
    s_cmp_ge_u32 s30, 2
    s_cbranch_scc1 mega_nopf1
    s_mul_i32 s36, s30, 54
    v_min_u32 v12, 53, v1
    v_add_u32 v12, s36, v12
    s_movk_i32 s36, 7282
    v_mul_u32_u24 v13, s36, v12
    v_lshrrev_b32 v13, 16, v13
    v_mul_u32_u24 v14, 9, v13
    v_sub_u32 v12, v12, v14
    v_lshlrev_b32 v12, 7, v12
    s_mov_b32 s36, 110592
    v_mad_u32_u24 v12, v13, s36, v12
    s_mul_i32 s36, s46, 1327104
    s_mul_i32 s37, s47, 1152
    s_add_u32 s36, s36, s37
    s_add_u32 s36, s36, 7620608
    buffer_load_dword v0, v12, s[16:19], s36 offen sc1
mega_nopf1:
    buffer_load_dwordx4 v[96:99], v11, s[20:23], s53 offen offset:0 sc1
    buffer_load_dwordx4 v[100:103], v11, s[20:23], s53 offen offset:1024 sc1
    buffer_load_dwordx4 v[104:107], v11, s[20:23], s53 offen offset:2048 sc1
    s_waitcnt vmcnt(0)
    s_branch ffn_join
mega_helper:
    s_setprio 1
    s_sub_u32 s31, s30, 8
    s_mov_b32 s20, s68
    s_mov_b32 s21, s69
    s_mov_b32 s22, 0xa2000
    s_mov_b32 s23, 0x00020000
    s_cmp_lg_u32 s31, 0
    s_cbranch_scc1 a_h_nopf
    v_min_u32 v12, 20, v1
    v_lshlrev_b32 v12, 7, v12
    s_mul_i32 s34, s2, 2592
    s_and_b32 s34, s34, 0xffffff80
    buffer_load_dword v21, v12, s[20:23], s34 offen
a_h_nopf:
    s_movk_i32 s40, 6554
    s_movk_i32 s41, 1152
    v_add_u32 v32, 0, v1
    v_mul_u32_u24 v33, s40, v32
    v_lshrrev_b32 v33, 16, v33
    v_mul_u32_u24 v34, 10, v33
    v_sub_u32 v34, v32, v34
    v_and_b32 v35, 8, v33
    v_lshrrev_b32 v35, 1, v35
    v_xor_b32 v35, v35, v33
    v_min_u32 v34, 8, v34
    v_mul_u32_u24 v16, s41, v35
    v_lshl_add_u32 v16, v34, 4, v16
    v_add_u32 v32, 64, v1
    v_mul_u32_u24 v33, s40, v32
    v_lshrrev_b32 v33, 16, v33
    v_mul_u32_u24 v34, 10, v33
    v_sub_u32 v34, v32, v34
    v_and_b32 v35, 8, v33
    v_lshrrev_b32 v35, 1, v35
    v_xor_b32 v35, v35, v33
    v_min_u32 v34, 8, v34
    v_mul_u32_u24 v17, s41, v35
    v_lshl_add_u32 v17, v34, 4, v17
    v_add_u32 v32, 128, v1
    v_mul_u32_u24 v33, s40, v32
    v_lshrrev_b32 v33, 16, v33
    v_mul_u32_u24 v34, 10, v33
    v_sub_u32 v34, v32, v34
    v_and_b32 v35, 8, v33
    v_lshrrev_b32 v35, 1, v35
    v_xor_b32 v35, v35, v33
    v_min_u32 v34, 8, v34
    v_mul_u32_u24 v18, s41, v35
    v_lshl_add_u32 v18, v34, 4, v18
    v_add_u32 v32, 192, v1
    v_mul_u32_u24 v33, s40, v32
    v_lshrrev_b32 v33, 16, v33
    v_mul_u32_u24 v34, 10, v33
    v_sub_u32 v34, v32, v34
    v_and_b32 v35, 8, v33
    v_lshrrev_b32 v35, 1, v35
    v_xor_b32 v35, v35, v33
    v_min_u32 v34, 8, v34
    v_mul_u32_u24 v19, s41, v35
    v_lshl_add_u32 v19, v34, 4, v19
    v_add_u32 v32, 256, v1
    v_mul_u32_u24 v33, s40, v32
    v_lshrrev_b32 v33, 16, v33
    v_mul_u32_u24 v34, 10, v33
    v_sub_u32 v34, v32, v34
    v_and_b32 v35, 8, v33
    v_lshrrev_b32 v35, 1, v35
    v_xor_b32 v35, v35, v33
    v_min_u32 v34, 8, v34
    v_mul_u32_u24 v20, s41, v35
    v_lshl_add_u32 v20, v34, 4, v20
    s_add_u32 s42, s31, s48
    s_mul_i32 s32, s29, 144
    s_mul_i32 s43, s31, 5120
    s_barrier
    s_sub_u32 s36, s42, 18
    s_min_u32 s42, s42, s36
    s_mul_i32 s36, s42, 36864
    s_add_u32 s36, s36, s32
    s_add_u32 m0, s43, 29696
    s_nop 0
    buffer_load_dwordx4 v16, s[20:23], s36 offen lds
    s_add_u32 m0, s43, 30720
    s_nop 0
    buffer_load_dwordx4 v17, s[20:23], s36 offen lds
    s_add_u32 m0, s43, 31744
    s_nop 0
    buffer_load_dwordx4 v18, s[20:23], s36 offen lds
    s_add_u32 m0, s43, 32768
    s_nop 0
    buffer_load_dwordx4 v19, s[20:23], s36 offen lds
    s_add_u32 m0, s43, 33792
    s_nop 0
    buffer_load_dwordx4 v20, s[20:23], s36 offen lds
    s_add_u32 s42, s42, 4
    s_sub_u32 s36, s42, 18
    s_min_u32 s42, s42, s36
    s_mul_i32 s36, s42, 36864
    s_add_u32 s36, s36, s32
    s_add_u32 m0, s43, 50176
    s_nop 0
    buffer_load_dwordx4 v16, s[20:23], s36 offen lds
    s_add_u32 m0, s43, 51200
    s_nop 0
    buffer_load_dwordx4 v17, s[20:23], s36 offen lds
    s_add_u32 m0, s43, 52224
    s_nop 0
    buffer_load_dwordx4 v18, s[20:23], s36 offen lds
    s_add_u32 m0, s43, 53248
    s_nop 0
    buffer_load_dwordx4 v19, s[20:23], s36 offen lds
    s_add_u32 m0, s43, 54272
    s_nop 0
    buffer_load_dwordx4 v20, s[20:23], s36 offen lds
    s_add_u32 s42, s42, 4
    s_waitcnt vmcnt(0)
    v_mov_b32 v12, 163392
    v_mov_b32 v13, 1
    s_mov_b32 exec_lo, 0x1
    s_mov_b32 exec_hi, 0x0
    ds_add_u32 v12, v13
    s_mov_b64 exec, -1
    v_mov_b32 v12, 163420
    s_mov_b32 s3, 524288
mega_lw_xc:
    ds_read_b32 v13, v12
    s_waitcnt lgkmcnt(0)
    v_readfirstlane_b32 s39, v13
    s_nop 0
    s_cmp_ge_u32 s39, 4
    s_cbranch_scc1 mega_lwd_xc
    s_sleep 1
    s_sub_u32 s3, s3, 1
    s_cbranch_scc0 mega_lw_xc
mega_lwd_xc:
    s_setprio 3
    s_sub_u32 s36, s42, 18
    s_min_u32 s42, s42, s36
    s_mul_i32 s36, s42, 36864
    s_add_u32 s36, s36, s32
    s_add_u32 m0, s43, 89088
    s_nop 0
    buffer_load_dwordx4 v16, s[20:23], s36 offen lds
    s_add_u32 m0, s43, 90112
    s_nop 0
    buffer_load_dwordx4 v17, s[20:23], s36 offen lds
    s_add_u32 m0, s43, 91136
    s_nop 0
    buffer_load_dwordx4 v18, s[20:23], s36 offen lds
    s_add_u32 m0, s43, 92160
    s_nop 0
    buffer_load_dwordx4 v19, s[20:23], s36 offen lds
    s_add_u32 m0, s43, 93184
    s_nop 0
    buffer_load_dwordx4 v20, s[20:23], s36 offen lds
    s_add_u32 s42, s42, 4
    s_sub_u32 s36, s42, 18
    s_min_u32 s42, s42, s36
    s_mul_i32 s36, s42, 36864
    s_add_u32 s36, s36, s32
    s_add_u32 m0, s43, 109568
    s_nop 0
    buffer_load_dwordx4 v16, s[20:23], s36 offen lds
    s_add_u32 m0, s43, 110592
    s_nop 0
    buffer_load_dwordx4 v17, s[20:23], s36 offen lds
    s_add_u32 m0, s43, 111616
    s_nop 0
    buffer_load_dwordx4 v18, s[20:23], s36 offen lds
    s_add_u32 m0, s43, 112640
    s_nop 0
    buffer_load_dwordx4 v19, s[20:23], s36 offen lds
    s_add_u32 m0, s43, 113664
    s_nop 0
    buffer_load_dwordx4 v20, s[20:23], s36 offen lds
    s_add_u32 s42, s42, 4
    s_cmp_ge_u32 s31, 2
    s_cbranch_scc1 a_h_skip
    s_sub_u32 s36, s42, 18
    s_min_u32 s42, s42, s36
    s_mul_i32 s36, s42, 36864
    s_add_u32 s36, s36, s32
    s_add_u32 m0, s43, 130048
    s_nop 0
    buffer_load_dwordx4 v16, s[20:23], s36 offen lds
    s_add_u32 m0, s43, 131072
    s_nop 0
    buffer_load_dwordx4 v17, s[20:23], s36 offen lds
    s_add_u32 m0, s43, 132096
    s_nop 0
    buffer_load_dwordx4 v18, s[20:23], s36 offen lds
    s_add_u32 m0, s43, 133120
    s_nop 0
    buffer_load_dwordx4 v19, s[20:23], s36 offen lds
    s_add_u32 m0, s43, 134144
    s_nop 0
    buffer_load_dwordx4 v20, s[20:23], s36 offen lds
    s_add_u32 s42, s42, 4
a_h_skip:
    s_waitcnt vmcnt(5)
    v_mov_b32 v12, 163396
    v_mov_b32 v13, 1
    s_mov_b32 exec_lo, 0x1
    s_mov_b32 exec_hi, 0x0
    ds_add_u32 v12, v13
    s_mov_b64 exec, -1
    s_waitcnt vmcnt(0)
    v_mov_b32 v12, 163400
    v_mov_b32 v13, 1
    s_mov_b32 exec_lo, 0x1
    s_mov_b32 exec_hi, 0x0
    ds_add_u32 v12, v13
    s_mov_b64 exec, -1
    v_mov_b32 v12, 163404
    s_mov_b32 s3, 524288
mega_lw_pub:
    ds_read_b32 v13, v12
    s_waitcnt lgkmcnt(0)
    v_readfirstlane_b32 s39, v13
    s_nop 0
    s_cmp_ge_u32 s39, 3
    s_cbranch_scc1 mega_lwd_pub
    s_sleep 1
    s_sub_u32 s3, s3, 1
    s_cbranch_scc0 mega_lw_pub
mega_lwd_pub:
    v_mov_b32 v12, 163432
    ds_read_b64 v[14:15], v12
    s_waitcnt lgkmcnt(0)
    v_readfirstlane_b32 s66, v14
    v_readfirstlane_b32 s67, v15
    v_lshrrev_b32 v10, 3, v1
    v_lshlrev_b32 v10, 7, v10
    v_and_b32 v9, 7, v1
    v_lshl_add_u32 v10, v9, 3, v10
    s_lshl_b32 s34, s31, 10
    s_add_u32 s35, s34, 7110656
    s_mov_b32 s3, 65536
mega_poll_k:
    s_sleep 10
    buffer_load_dwordx2 v[14:15], v10, s[16:19], s35 offen sc1
    s_waitcnt vmcnt(0)
    v_cmp_eq_u32 vcc, s66, v14
    s_nop 0
    s_cmp_eq_u64 vcc, -1
    s_cbranch_scc1 mega_polld_k
    s_sub_u32 s3, s3, 1
    s_cbranch_scc0 mega_poll_k
mega_polld_k:
    v_mov_b32 v12, 163412
    ds_max_u32 v12, v15
    v_mov_b32 v12, 163408
    v_mov_b32 v13, 1
    s_mov_b32 exec_lo, 0x1
    s_mov_b32 exec_hi, 0x0
    ds_add_u32 v12, v13
    s_mov_b64 exec, -1
    s_lshr_b32 s35, s2, 3
    s_add_u32 s35, s35, s2
    s_and_b32 s35, s35, 15
    s_mul_i32 s35, s35, 9488
    s_add_u32 s35, s35, s34
    v_add_u32 v10, 45481984, v11
    v_mov_b32 v12, 163408
    s_mov_b32 s3, 524288
mega_lw_kvr:
    ds_read_b32 v13, v12
    s_waitcnt lgkmcnt(0)
    v_readfirstlane_b32 s39, v13
    s_nop 0
    s_cmp_ge_u32 s39, 4
    s_cbranch_scc1 mega_lwd_kvr
    s_sleep 1
    s_sub_u32 s3, s3, 1
    s_cbranch_scc0 mega_lw_kvr
mega_lwd_kvr:
    s_or_b32 s36, s2, s31
    s_cmp_lg_u32 s36, 0
    s_cbranch_scc1 a_h_noclr
    s_mov_b32 s56, s74
    s_mov_b32 s57, s75
    s_mov_b32 s58, 0x100
    s_mov_b32 s59, 0x00020000
    v_mov_b32 v12, 0
    v_mov_b32 v13, 0
    s_mov_b32 exec_lo, 0x1
    s_mov_b32 exec_hi, 0x0
    buffer_store_dwordx2 v[12:13], v12, s[56:59], 0 offen sc1
    s_mov_b64 exec, -1
a_h_noclr:
    s_add_u32 m0, s34, 0
    s_sub_u32 s36, s35, 147712
    buffer_load_dwordx4 v10, s[16:19], s35 offen sc1 lds
    s_add_u32 s35, s35, 4096
    s_min_u32 s35, s35, s36
    s_add_u32 m0, s34, 4096
    s_sub_u32 s36, s35, 147712
    buffer_load_dwordx4 v10, s[16:19], s35 offen sc1 lds
    s_add_u32 s35, s35, 4096
    s_min_u32 s35, s35, s36
    s_add_u32 m0, s34, 8192
    s_sub_u32 s36, s35, 147712
    buffer_load_dwordx4 v10, s[16:19], s35 offen sc1 lds
    s_add_u32 s35, s35, 4096
    s_min_u32 s35, s35, s36
    s_add_u32 m0, s34, 12288
    s_sub_u32 s36, s35, 147712
    buffer_load_dwordx4 v10, s[16:19], s35 offen sc1 lds
    s_add_u32 s35, s35, 4096
    s_min_u32 s35, s35, s36
    s_add_u32 m0, s34, 16384
    s_sub_u32 s36, s35, 147712
    buffer_load_dwordx4 v10, s[16:19], s35 offen sc1 lds
    s_add_u32 s35, s35, 4096
    s_min_u32 s35, s35, s36
    s_add_u32 m0, s34, 20480
    s_sub_u32 s36, s35, 147712
    buffer_load_dwordx4 v10, s[16:19], s35 offen sc1 lds
    s_add_u32 s35, s35, 4096
    s_min_u32 s35, s35, s36
    s_add_u32 m0, s34, 24576
    s_sub_u32 s36, s35, 147712
    buffer_load_dwordx4 v10, s[16:19], s35 offen sc1 lds
    s_add_u32 s35, s35, 4096
    s_min_u32 s35, s35, s36
    s_waitcnt vmcnt(0)
    v_mov_b32 v12, 163468
    v_mov_b32 v13, 1
    s_mov_b32 exec_lo, 0x1
    s_mov_b32 exec_hi, 0x0
    ds_add_u32 v12, v13
    s_mov_b64 exec, -1
    v_mov_b32 v12, 163464
    s_mov_b32 s3, 524288
mega_lw_wdn:
    ds_read_b32 v13, v12
    s_waitcnt lgkmcnt(0)
    v_readfirstlane_b32 s39, v13
    s_nop 0
    s_cmp_ge_u32 s39, 4
    s_cbranch_scc1 mega_lwd_wdn
    s_sleep 1
    s_sub_u32 s3, s3, 1
    s_cbranch_scc0 mega_lw_wdn
mega_lwd_wdn:
    s_add_u32 m0, s34, 28672
    s_sub_u32 s36, s35, 147712
    buffer_load_dwordx4 v10, s[16:19], s35 offen sc1 lds
    s_add_u32 s35, s35, 4096
    s_min_u32 s35, s35, s36
    s_add_u32 m0, s34, 32768
    s_sub_u32 s36, s35, 147712
    buffer_load_dwordx4 v10, s[16:19], s35 offen sc1 lds
    s_add_u32 s35, s35, 4096
    s_min_u32 s35, s35, s36
    s_add_u32 m0, s34, 36864
    s_sub_u32 s36, s35, 147712
    buffer_load_dwordx4 v10, s[16:19], s35 offen sc1 lds
    s_add_u32 s35, s35, 4096
    s_min_u32 s35, s35, s36
    s_add_u32 m0, s34, 40960
    s_sub_u32 s36, s35, 147712
    buffer_load_dwordx4 v10, s[16:19], s35 offen sc1 lds
    s_add_u32 s35, s35, 4096
    s_min_u32 s35, s35, s36
    s_add_u32 m0, s34, 45056
    s_sub_u32 s36, s35, 147712
    buffer_load_dwordx4 v10, s[16:19], s35 offen sc1 lds
    s_add_u32 s35, s35, 4096
    s_min_u32 s35, s35, s36
    s_add_u32 m0, s34, 49152
    s_sub_u32 s36, s35, 147712
    buffer_load_dwordx4 v10, s[16:19], s35 offen sc1 lds
    s_add_u32 s35, s35, 4096
    s_min_u32 s35, s35, s36
    s_add_u32 m0, s34, 53248
    s_sub_u32 s36, s35, 147712
    buffer_load_dwordx4 v10, s[16:19], s35 offen sc1 lds
    s_add_u32 s35, s35, 4096
    s_min_u32 s35, s35, s36
    s_add_u32 m0, s34, 57344
    s_sub_u32 s36, s35, 147712
    buffer_load_dwordx4 v10, s[16:19], s35 offen sc1 lds
    s_add_u32 s35, s35, 4096
    s_min_u32 s35, s35, s36
    s_add_u32 m0, s34, 61440
    s_sub_u32 s36, s35, 147712
    buffer_load_dwordx4 v10, s[16:19], s35 offen sc1 lds
    s_add_u32 s35, s35, 4096
    s_min_u32 s35, s35, s36
    s_add_u32 m0, s34, 65536
    s_sub_u32 s36, s35, 147712
    buffer_load_dwordx4 v10, s[16:19], s35 offen sc1 lds
    s_add_u32 s35, s35, 4096
    s_min_u32 s35, s35, s36
    s_add_u32 m0, s34, 69632
    s_sub_u32 s36, s35, 147712
    buffer_load_dwordx4 v10, s[16:19], s35 offen sc1 lds
    s_add_u32 s35, s35, 4096
    s_min_u32 s35, s35, s36
    s_add_u32 m0, s34, 73728
    s_sub_u32 s36, s35, 147712
    buffer_load_dwordx4 v10, s[16:19], s35 offen sc1 lds
    s_add_u32 s35, s35, 4096
    s_min_u32 s35, s35, s36
    s_add_u32 m0, s34, 77824
    s_sub_u32 s36, s35, 147712
    buffer_load_dwordx4 v10, s[16:19], s35 offen sc1 lds
    s_add_u32 s35, s35, 4096
    s_min_u32 s35, s35, s36
    s_add_u32 m0, s34, 81920
    s_sub_u32 s36, s35, 147712
    buffer_load_dwordx4 v10, s[16:19], s35 offen sc1 lds
    s_add_u32 s35, s35, 4096
    s_min_u32 s35, s35, s36
    s_add_u32 m0, s34, 86016
    s_sub_u32 s36, s35, 147712
    buffer_load_dwordx4 v10, s[16:19], s35 offen sc1 lds
    s_add_u32 s35, s35, 4096
    s_min_u32 s35, s35, s36
    s_add_u32 m0, s34, 90112
    s_sub_u32 s36, s35, 147712
    buffer_load_dwordx4 v10, s[16:19], s35 offen sc1 lds
    s_add_u32 s35, s35, 4096
    s_min_u32 s35, s35, s36
    s_add_u32 m0, s34, 94208
    s_sub_u32 s36, s35, 147712
    buffer_load_dwordx4 v10, s[16:19], s35 offen sc1 lds
    s_add_u32 s35, s35, 4096
    s_min_u32 s35, s35, s36
    s_add_u32 m0, s34, 98304
    s_sub_u32 s36, s35, 147712
    buffer_load_dwordx4 v10, s[16:19], s35 offen sc1 lds
    s_add_u32 s35, s35, 4096
    s_min_u32 s35, s35, s36
    s_add_u32 m0, s34, 102400
    s_sub_u32 s36, s35, 147712
    buffer_load_dwordx4 v10, s[16:19], s35 offen sc1 lds
    s_add_u32 s35, s35, 4096
    s_min_u32 s35, s35, s36
    s_add_u32 m0, s34, 106496
    s_sub_u32 s36, s35, 147712
    buffer_load_dwordx4 v10, s[16:19], s35 offen sc1 lds
    s_add_u32 s35, s35, 4096
    s_min_u32 s35, s35, s36
    s_add_u32 m0, s34, 110592
    s_sub_u32 s36, s35, 147712
    buffer_load_dwordx4 v10, s[16:19], s35 offen sc1 lds
    s_add_u32 s35, s35, 4096
    s_min_u32 s35, s35, s36
    s_add_u32 m0, s34, 114688
    s_sub_u32 s36, s35, 147712
    buffer_load_dwordx4 v10, s[16:19], s35 offen sc1 lds
    s_add_u32 s35, s35, 4096
    s_min_u32 s35, s35, s36
    s_add_u32 m0, s34, 118784
    s_sub_u32 s36, s35, 147712
    buffer_load_dwordx4 v10, s[16:19], s35 offen sc1 lds
    s_add_u32 s35, s35, 4096
    s_min_u32 s35, s35, s36
    s_add_u32 m0, s34, 122880
    s_sub_u32 s36, s35, 147712
    buffer_load_dwordx4 v10, s[16:19], s35 offen sc1 lds
    s_add_u32 s35, s35, 4096
    s_min_u32 s35, s35, s36
    s_add_u32 m0, s34, 126976
    s_sub_u32 s36, s35, 147712
    buffer_load_dwordx4 v10, s[16:19], s35 offen sc1 lds
    s_add_u32 s35, s35, 4096
    s_min_u32 s35, s35, s36
    s_add_u32 m0, s34, 131072
    s_sub_u32 s36, s35, 147712
    buffer_load_dwordx4 v10, s[16:19], s35 offen sc1 lds
    s_add_u32 s35, s35, 4096
    s_min_u32 s35, s35, s36
    s_add_u32 m0, s34, 135168
    s_sub_u32 s36, s35, 147712
    buffer_load_dwordx4 v10, s[16:19], s35 offen sc1 lds
    s_add_u32 s35, s35, 4096
    s_min_u32 s35, s35, s36
    s_add_u32 m0, s34, 139264
    s_sub_u32 s36, s35, 147712
    buffer_load_dwordx4 v10, s[16:19], s35 offen sc1 lds
    s_add_u32 s35, s35, 4096
    s_min_u32 s35, s35, s36
    s_add_u32 m0, s34, 143360
    s_sub_u32 s36, s35, 147712
    buffer_load_dwordx4 v10, s[16:19], s35 offen sc1 lds
    s_add_u32 s35, s35, 4096
    s_min_u32 s35, s35, s36
    s_add_u32 m0, s34, 147456
    s_sub_u32 s36, s35, 147712
    buffer_load_dwordx4 v10, s[16:19], s35 offen sc1 lds
    s_add_u32 s35, s35, 4096
    s_min_u32 s35, s35, s36
    s_cmp_lg_u32 s31, 0
    s_cbranch_scc1 mega_h_nolast
    s_mov_b32 exec_lo, 0xffff
    s_mov_b32 exec_hi, 0x0
    s_add_u32 m0, s34, 151552
    s_sub_u32 s36, s35, 147712
    buffer_load_dwordx4 v10, s[16:19], s35 offen sc1 lds
    s_add_u32 s35, s35, 4096
    s_min_u32 s35, s35, s36
    s_mov_b64 exec, -1
mega_h_nolast:
    s_lshl_b32 s34, s31, 6
    v_add_u32 v12, s34, v1
    v_min_u32 v12, 161, v12
    v_lshlrev_b32 v12, 7, v12
    s_mul_i32 s34, s47, 20736
    s_lshl_b32 s50, s31, 5
    s_add_u32 s50, s50, s47
    s_cmp_ge_u32 s50, 54
    s_cselect_b32 s53, 1, 0
    s_mul_i32 s51, s53, 54
    s_sub_u32 s51, s50, s51
    s_mul_i32 s54, s51, 57
    s_lshr_b32 s54, s54, 10
    s_mul_i32 s52, s54, 18
    s_sub_u32 s52, s51, s52
    s_cmp_eq_u32 s53, 0
    s_cselect_b32 s20, s4, s6
    s_cselect_b32 s21, s5, s7
    s_mov_b32 s22, 0x510000
    s_mov_b32 s23, 0x00020000
    s_movk_i32 s56, 1152
    s_cselect_b32 s56, 9216, s56
    s_movk_i32 s57, 1152
    s_cselect_b32 s57, s57, 663552
    s_mul_i32 s57, s57, s46
    s_movk_i32 s58, 128
    s_cselect_b32 s58, 192, s58
    s_mul_i32 s58, s58, s54
    s_mul_i32 s58, s58, s56
    s_add_u32 s57, s57, s58
    s_lshl_b32 s58, s52, 6
    s_add_u32 s57, s57, s58
    s_cmp_eq_u32 s53, 1
    s_cselect_b32 s58, 2, 1
    s_cselect_b32 s59, -5, 1
    s_mul_i32 s58, s58, s56
    s_mul_i32 s59, s59, s56
    s_mul_i32 s60, s56, 25
    s_lshl_b32 s55, s54, 6
    s_sub_u32 s55, 256, s55
    s_mul_i32 s55, s55, s53
    s_add_u32 s55, s55, 25
    s_mul_i32 s55, s55, s56
    v_lshrrev_b32 v2, 4, v1
    v_lshlrev_b32 v2, 3, v2
    v_mul_u32_u24 v15, s56, v2
    v_and_b32 v3, 15, v1
    v_lshl_add_u32 v15, v3, 2, v15
    v_lshlrev_b32 v8, 2, v3
    s_mov_b32 s64, 0x05040100
    s_mov_b32 s65, 0x07060302
    s_mul_i32 s62, s52, 110592
    s_mul_i32 s63, s52, 221184
    s_sub_u32 s63, s63, 2652160
    s_cmp_lt_u32 s52, 12
    s_cselect_b32 s62, s62, s63
    s_movk_i32 s61, 1024
    s_cselect_b32 s61, s61, 110592
    s_mul_i32 s63, s53, 3
    s_add_u32 s63, s63, s54
    s_mul_i32 s63, s63, 18432
    s_add_u32 s62, s62, s63
    s_mul_i32 s63, s46, 1327104
    s_add_u32 s62, s62, s63
    s_add_u32 s62, s62, 7602176
    s_add_u32 s61, s61, s62
    v_mov_b32 v152, 0x3f803f80
    v_mov_b32 v153, 0x3f803f80
    v_mov_b32 v154, 0x3f803f80
    v_mov_b32 v155, 0x3f803f80
    s_waitcnt vmcnt(0)
    v_mov_b32 v9, 163444
    v_mov_b32 v10, 1
    s_mov_b32 exec_lo, 0x1
    s_mov_b32 exec_hi, 0x0
    ds_add_u32 v9, v10
    s_mov_b64 exec, -1
    buffer_load_dword v13, v12, s[24:27], s34 offen
    s_cmp_ge_u32 s50, 108
    s_cbranch_scc1 mega_h_nounit
    buffer_load_dword v48, v15, s[20:23], s57 offen
    s_add_u32 s57, s57, s56
    buffer_load_dword v49, v15, s[20:23], s57 offen
    s_add_u32 s57, s57, s56
    buffer_load_dword v50, v15, s[20:23], s57 offen
    s_add_u32 s57, s57, s56
    buffer_load_dword v51, v15, s[20:23], s57 offen
    s_add_u32 s57, s57, s56
    buffer_load_dword v52, v15, s[20:23], s57 offen
    s_add_u32 s57, s57, s56
    buffer_load_dword v53, v15, s[20:23], s57 offen
    s_add_u32 s57, s57, s56
    buffer_load_dword v54, v15, s[20:23], s57 offen
    s_add_u32 s57, s57, s56
    buffer_load_dword v55, v15, s[20:23], s57 offen
    s_add_u32 s57, s57, s60
    buffer_load_dword v56, v15, s[20:23], s57 offen
    s_add_u32 s57, s57, s56
    buffer_load_dword v57, v15, s[20:23], s57 offen
    s_add_u32 s57, s57, s56
    buffer_load_dword v58, v15, s[20:23], s57 offen
    s_add_u32 s57, s57, s56
    buffer_load_dword v59, v15, s[20:23], s57 offen
    s_add_u32 s57, s57, s56
    buffer_load_dword v60, v15, s[20:23], s57 offen
    s_add_u32 s57, s57, s56
    buffer_load_dword v61, v15, s[20:23], s57 offen
    s_add_u32 s57, s57, s56
    buffer_load_dword v62, v15, s[20:23], s57 offen
    s_add_u32 s57, s57, s56
    buffer_load_dword v63, v15, s[20:23], s57 offen
    s_add_u32 s57, s57, s60
    buffer_load_dword v64, v15, s[20:23], s57 offen
    s_add_u32 s57, s57, s56
    buffer_load_dword v65, v15, s[20:23], s57 offen
    s_add_u32 s57, s57, s56
    buffer_load_dword v66, v15, s[20:23], s57 offen
    s_add_u32 s57, s57, s56
    buffer_load_dword v67, v15, s[20:23], s57 offen
    s_add_u32 s57, s57, s56
    buffer_load_dword v68, v15, s[20:23], s57 offen
    s_add_u32 s57, s57, s56
    buffer_load_dword v69, v15, s[20:23], s57 offen
    s_add_u32 s57, s57, s56
    buffer_load_dword v70, v15, s[20:23], s57 offen
    s_add_u32 s57, s57, s56
    buffer_load_dword v71, v15, s[20:23], s57 offen
    s_add_u32 s57, s57, s60
    buffer_load_dword v72, v15, s[20:23], s57 offen
    s_add_u32 s57, s57, s56
    buffer_load_dword v73, v15, s[20:23], s57 offen
    s_add_u32 s57, s57, s56
    buffer_load_dword v74, v15, s[20:23], s57 offen
    s_add_u32 s57, s57, s56
    buffer_load_dword v75, v15, s[20:23], s57 offen
    s_add_u32 s57, s57, s56
    buffer_load_dword v76, v15, s[20:23], s57 offen
    s_add_u32 s57, s57, s56
    buffer_load_dword v77, v15, s[20:23], s57 offen
    s_add_u32 s57, s57, s56
    buffer_load_dword v78, v15, s[20:23], s57 offen
    s_add_u32 s57, s57, s56
    buffer_load_dword v79, v15, s[20:23], s57 offen
    s_add_u32 s57, s57, s55
    buffer_load_dword v80, v15, s[20:23], s57 offen
    s_add_u32 s57, s57, s58
    buffer_load_dword v81, v15, s[20:23], s57 offen
    s_add_u32 s57, s57, s58
    buffer_load_dword v82, v15, s[20:23], s57 offen
    s_add_u32 s57, s57, s58
    buffer_load_dword v83, v15, s[20:23], s57 offen
    s_add_u32 s57, s57, s59
    buffer_load_dword v84, v15, s[20:23], s57 offen
    s_add_u32 s57, s57, s58
    buffer_load_dword v85, v15, s[20:23], s57 offen
    s_add_u32 s57, s57, s58
    buffer_load_dword v86, v15, s[20:23], s57 offen
    s_add_u32 s57, s57, s58
    buffer_load_dword v87, v15, s[20:23], s57 offen
    s_add_u32 s57, s57, s60
    buffer_load_dword v88, v15, s[20:23], s57 offen
    s_add_u32 s57, s57, s58
    buffer_load_dword v89, v15, s[20:23], s57 offen
    s_add_u32 s57, s57, s58
    buffer_load_dword v90, v15, s[20:23], s57 offen
    s_add_u32 s57, s57, s58
    buffer_load_dword v91, v15, s[20:23], s57 offen
    s_add_u32 s57, s57, s59
    buffer_load_dword v92, v15, s[20:23], s57 offen
    s_add_u32 s57, s57, s58
    buffer_load_dword v93, v15, s[20:23], s57 offen
    s_add_u32 s57, s57, s58
    buffer_load_dword v94, v15, s[20:23], s57 offen
    s_add_u32 s57, s57, s58
    buffer_load_dword v95, v15, s[20:23], s57 offen
    s_add_u32 s57, s57, s60
    s_waitcnt vmcnt(40)
    v_perm_b32 v96, v49, v48, s64
    v_perm_b32 v97, v51, v50, s64
    v_perm_b32 v98, v53, v52, s64
    v_perm_b32 v99, v55, v54, s64
    buffer_store_dwordx4 v[96:99], v11, s[16:19], s62 offen sc1
    s_add_u32 s62, s62, 3072
    v_perm_b32 v100, v49, v48, s65
    v_perm_b32 v101, v51, v50, s65
    v_perm_b32 v102, v53, v52, s65
    v_perm_b32 v103, v55, v54, s65
    buffer_store_dwordx4 v[100:103], v11, s[16:19], s61 offen sc1
    s_add_u32 s61, s61, 3072
    s_waitcnt vmcnt(34)
    v_perm_b32 v104, v57, v56, s64
    v_perm_b32 v105, v59, v58, s64
    v_perm_b32 v106, v61, v60, s64
    v_perm_b32 v107, v63, v62, s64
    buffer_store_dwordx4 v[104:107], v11, s[16:19], s62 offen sc1
    s_add_u32 s62, s62, 3072
    v_perm_b32 v108, v57, v56, s65
    v_perm_b32 v109, v59, v58, s65
    v_perm_b32 v110, v61, v60, s65
    v_perm_b32 v111, v63, v62, s65
    buffer_store_dwordx4 v[108:111], v11, s[16:19], s61 offen sc1
    s_add_u32 s61, s61, 3072
    s_waitcnt vmcnt(28)
    v_perm_b32 v112, v65, v64, s64
    v_perm_b32 v113, v67, v66, s64
    v_perm_b32 v114, v69, v68, s64
    v_perm_b32 v115, v71, v70, s64
    buffer_store_dwordx4 v[112:115], v11, s[16:19], s62 offen sc1
    s_add_u32 s62, s62, 3072
    v_perm_b32 v116, v65, v64, s65
    v_perm_b32 v117, v67, v66, s65
    v_perm_b32 v118, v69, v68, s65
    v_perm_b32 v119, v71, v70, s65
    buffer_store_dwordx4 v[116:119], v11, s[16:19], s61 offen sc1
    s_add_u32 s61, s61, 3072
    s_waitcnt vmcnt(22)
    v_perm_b32 v120, v73, v72, s64
    v_perm_b32 v121, v75, v74, s64
    v_perm_b32 v122, v77, v76, s64
    v_perm_b32 v123, v79, v78, s64
    buffer_store_dwordx4 v[120:123], v11, s[16:19], s62 offen sc1
    s_add_u32 s62, s62, 3072
    v_perm_b32 v124, v73, v72, s65
    v_perm_b32 v125, v75, v74, s65
    v_perm_b32 v126, v77, v76, s65
    v_perm_b32 v127, v79, v78, s65
    buffer_store_dwordx4 v[124:127], v11, s[16:19], s61 offen sc1
    s_add_u32 s61, s61, 3072
    s_waitcnt vmcnt(16)
    v_perm_b32 v128, v81, v80, s64
    v_perm_b32 v129, v83, v82, s64
    v_perm_b32 v130, v85, v84, s64
    v_perm_b32 v131, v87, v86, s64
    buffer_store_dwordx4 v[128:131], v11, s[16:19], s62 offen sc1
    s_add_u32 s62, s62, 3072
    v_perm_b32 v132, v81, v80, s65
    v_perm_b32 v133, v83, v82, s65
    v_perm_b32 v134, v85, v84, s65
    v_perm_b32 v135, v87, v86, s65
    buffer_store_dwordx4 v[132:135], v11, s[16:19], s61 offen sc1
    s_add_u32 s61, s61, 3072
    s_waitcnt vmcnt(10)
    v_perm_b32 v136, v89, v88, s64
    v_perm_b32 v137, v91, v90, s64
    v_perm_b32 v138, v93, v92, s64
    v_perm_b32 v139, v95, v94, s64
    buffer_store_dwordx4 v[136:139], v11, s[16:19], s62 offen sc1
    s_add_u32 s62, s62, 3072
    v_perm_b32 v140, v89, v88, s65
    v_perm_b32 v141, v91, v90, s65
    v_perm_b32 v142, v93, v92, s65
    v_perm_b32 v143, v95, v94, s65
    buffer_store_dwordx4 v[140:143], v11, s[16:19], s61 offen sc1
    s_add_u32 s61, s61, 3072
    s_cmp_lg_u32 s53, 0
    s_cbranch_scc1 mega_h_nounit
    v_mfma_f32_16x16x32_bf16 v[144:147], v[152:155], v[96:99], 0
    v_mfma_f32_16x16x32_bf16 v[148:151], v[152:155], v[100:103], 0
    v_mfma_f32_16x16x32_bf16 v[144:147], v[152:155], v[104:107], v[144:147]
    v_mfma_f32_16x16x32_bf16 v[148:151], v[152:155], v[108:111], v[148:151]
    v_mfma_f32_16x16x32_bf16 v[144:147], v[152:155], v[112:115], v[144:147]
    v_mfma_f32_16x16x32_bf16 v[148:151], v[152:155], v[116:119], v[148:151]
    v_mfma_f32_16x16x32_bf16 v[144:147], v[152:155], v[120:123], v[144:147]
    v_mfma_f32_16x16x32_bf16 v[148:151], v[152:155], v[124:127], v[148:151]
    v_mfma_f32_16x16x32_bf16 v[144:147], v[152:155], v[128:131], v[144:147]
    v_mfma_f32_16x16x32_bf16 v[148:151], v[152:155], v[132:135], v[148:151]
    v_mfma_f32_16x16x32_bf16 v[144:147], v[152:155], v[136:139], v[144:147]
    v_mfma_f32_16x16x32_bf16 v[148:151], v[152:155], v[140:143], v[148:151]
    s_mul_i32 s58, s54, 18432
    s_mul_i32 s59, s46, 2304
    s_add_u32 s58, s58, s59
    s_lshl_b32 s59, s52, 7
    s_add_u32 s58, s58, s59
    s_add_u32 s58, s58, 7405568
    s_mov_b32 exec_lo, 0xffff
    s_mov_b32 exec_hi, 0x0
    buffer_store_dword v144, v8, s[16:19], s58 offen sc1
    buffer_store_dword v148, v8, s[16:19], s58 offen offset:64 sc1
    s_mov_b64 exec, -1
mega_h_nounit:
    s_waitcnt vmcnt(0)
    s_lshl_b32 s34, s46, 9
    s_add_u32 s36, s34, 7086080
    s_lshr_b32 s35, s47, 3
    s_lshl_b32 s35, s35, 7
    s_add_u32 s34, s36, s35
    s_lshl_b32 s35, s29, 3
    s_add_u32 s34, s34, s35
    v_mov_b32 v12, 163344
    v_mov_b32 v13, 1
    s_mov_b32 exec_lo, 0x1
    s_mov_b32 exec_hi, 0x0
    ds_add_rtn_u32 v14, v12, v13
    s_mov_b64 exec, -1
    s_waitcnt lgkmcnt(0)
    v_readfirstlane_b32 s3, v14
    s_nop 0
    s_cmp_lg_u32 s3, 3
    s_cbranch_scc1 mega_arr_p
    v_mov_b32 v12, 0
    v_mov_b32 v14, s66
    v_mov_b32 v15, s67
    s_mov_b32 exec_lo, 0x1
    s_mov_b32 exec_hi, 0x0
    buffer_store_dwordx2 v[14:15], v12, s[16:19], s34 offen sc1
    s_mov_b64 exec, -1
mega_arr_p:
    s_cmp_lg_u32 s31, 3
    s_cbranch_scc1 mega_h_nofp
    v_mov_b32 v12, 163456
    s_mov_b32 s3, 524288
mega_lw_qa:
    ds_read_b32 v13, v12
    s_waitcnt lgkmcnt(0)
    v_readfirstlane_b32 s39, v13
    s_nop 0
    s_cmp_ge_u32 s39, 2
    s_cbranch_scc1 mega_lwd_qa
    s_sleep 1
    s_sub_u32 s3, s3, 1
    s_cbranch_scc0 mega_lw_qa
mega_lwd_qa:
    v_mov_b32 v12, 163460
    s_mov_b32 s3, 524288
mega_lw_qb:
    ds_read_b32 v13, v12
    s_waitcnt lgkmcnt(0)
    v_readfirstlane_b32 s39, v13
    s_nop 0
    s_cmp_ge_u32 s39, 2
    s_cbranch_scc1 mega_lwd_qb
    s_sleep 1
    s_sub_u32 s3, s3, 1
    s_cbranch_scc0 mega_lw_qb
mega_lwd_qb:
    v_bfe_u32 v12, v1, 3, 2
    v_lshlrev_b32 v12, 7, v12
    v_and_b32 v13, 7, v1
    v_lshl_add_u32 v12, v13, 3, v12
    s_mov_b32 s3, 65536
mega_poll_p:
    s_sleep 16
    buffer_load_dwordx2 v[14:15], v12, s[16:19], s36 offen sc1
    s_waitcnt vmcnt(0)
    v_cmp_eq_u64 vcc, s[66:67], v[14:15]
    s_nop 0
    s_cmp_eq_u64 vcc, -1
    s_cbranch_scc1 mega_polld_p
    s_sub_u32 s3, s3, 1
    s_cbranch_scc0 mega_poll_p
mega_polld_p:
    v_add_u32 v13, 128, v1
    v_min_u32 v13, 143, v13
    v_lshlrev_b32 v13, 4, v13
    s_mul_i32 s34, s46, 2304
    s_add_u32 s34, s34, 7405568
    buffer_load_dwordx4 v[48:51], v11, s[16:19], s34 offen sc1
    buffer_load_dwordx4 v[52:55], v11, s[16:19], s34 offen offset:1024 sc1
    buffer_load_dwordx4 v[56:59], v13, s[16:19], s34 offen sc1
    s_add_u32 s34, s34, 18432
    buffer_load_dwordx4 v[60:63], v11, s[16:19], s34 offen sc1
    buffer_load_dwordx4 v[64:67], v11, s[16:19], s34 offen offset:1024 sc1
    buffer_load_dwordx4 v[68:71], v13, s[16:19], s34 offen sc1
    s_add_u32 s34, s34, 18432
    buffer_load_dwordx4 v[72:75], v11, s[16:19], s34 offen sc1
    buffer_load_dwordx4 v[76:79], v11, s[16:19], s34 offen offset:1024 sc1
    buffer_load_dwordx4 v[80:83], v13, s[16:19], s34 offen sc1
    s_add_u32 s34, s34, 18432
    v_mov_b32 v14, 163328
    v_mov_b32 v15, 1
    ds_write_b32 v14, v15
    v_lshlrev_b32 v14, 7, v1
    v_and_b32 v15, 3, v1
    v_lshlrev_b32 v15, 7, v15
    s_mul_i32 s34, s46, 1327104
    s_mul_i32 s35, s47, 41472
    s_add_u32 s34, s34, s35
    s_add_u32 s34, s34, 7602176
    buffer_load_dword v96, v14, s[16:19], s34 offen sc1
    s_add_u32 s34, s34, 8192
    buffer_load_dword v97, v14, s[16:19], s34 offen sc1
    s_add_u32 s34, s34, 8192
    buffer_load_dword v98, v14, s[16:19], s34 offen sc1
    s_add_u32 s34, s34, 8192
    buffer_load_dword v99, v14, s[16:19], s34 offen sc1
    s_add_u32 s34, s34, 8192
    buffer_load_dword v100, v14, s[16:19], s34 offen sc1
    s_add_u32 s34, s34, 8192
    buffer_load_dword v101, v15, s[16:19], s34 offen sc1
    s_add_u32 s34, s34, 8192
    v_add_u32 v12, 161024, v11
    v_add_u32 v13, 161024, v13
    s_waitcnt vmcnt(6)
    v_add_f32 v48, v48, v60
    v_add_f32 v49, v49, v61
    v_add_f32 v50, v50, v62
    v_add_f32 v51, v51, v63
    v_add_f32 v52, v52, v64
    v_add_f32 v53, v53, v65
    v_add_f32 v54, v54, v66
    v_add_f32 v55, v55, v67
    v_add_f32 v56, v56, v68
    v_add_f32 v57, v57, v69
    v_add_f32 v58, v58, v70
    v_add_f32 v59, v59, v71
    v_add_f32 v48, v48, v72
    v_add_f32 v49, v49, v73
    v_add_f32 v50, v50, v74
    v_add_f32 v51, v51, v75
    v_add_f32 v52, v52, v76
    v_add_f32 v53, v53, v77
    v_add_f32 v54, v54, v78
    v_add_f32 v55, v55, v79
    v_add_f32 v56, v56, v80
    v_add_f32 v57, v57, v81
    v_add_f32 v58, v58, v82
    v_add_f32 v59, v59, v83
    ds_write_b128 v12, v[48:51]
    ds_write_b128 v12, v[52:55] offset:1024
    ds_write_b128 v13, v[56:59]
    s_waitcnt lgkmcnt(0)
mega_h_nofp:
    v_and_b32 v2, 15, v1
    v_lshrrev_b32 v3, 4, v1
    v_lshrrev_b32 v32, 2, v2
    v_and_b32 v33, 1, v3
    v_lshlrev_b32 v33, 2, v33
    v_add_u32 v32, v32, v33
    v_lshl_add_u32 v32, v3, 3, v32
    v_xor_b32 v33, 4, v32
    s_movk_i32 s40, 160
    v_and_b32 v34, 3, v2
    v_lshlrev_b32 v34, 3, v34
    v_add_u32 v34, 0, v34
    v_mad_u32_u24 v28, v32, s40, v34
    v_mad_u32_u24 v29, v33, s40, v34
    v_add_u32 v30, 61440, v11
    s_mul_i32 s44, s31, 2560
    s_add_u32 s44, s44, 92160
    v_and_b32 v21, 8, v2
    v_lshrrev_b32 v21, 1, v21
    v_xor_b32 v21, v21, v2
    v_mul_u32_u24 v21, s40, v21
    v_lshl_add_u32 v21, v3, 3, v21
    v_add_u32 v21, s44, v21
    v_and_b32 v22, 1, v3
    v_lshlrev_b32 v22, 9, v22
    v_lshrrev_b32 v32, 1, v3
    v_lshl_add_u32 v22, v32, 8, v22
    v_lshl_add_u32 v22, v2, 4, v22
    v_and_b32 v23, 7, v1
    v_lshlrev_b32 v23, 3, v23
    s_lshl_b32 s48, s28, 2
    s_add_u32 s48, s48, s31
    s_mul_i32 s49, s48, 18432
    s_mul_i32 s68, s28, 0
    s_add_u32 s68, s68, s49
    s_add_u32 s34, s68, 2359296
    v_add_u32 v24, s34, v11
    s_lshl_b32 s51, s29, 11
    v_mov_b32 v12, 163428
    s_mov_b32 s3, 524288
mega_rel:
    ds_read_b32 v13, v12
    s_waitcnt lgkmcnt(0)
    v_readfirstlane_b32 s50, v13
    s_nop 0
    s_and_b32 s39, s50, 0xff
    s_cmp_ge_u32 s39, 8
    s_cbranch_scc1 mega_reld
    s_sleep 4
    s_sub_u32 s3, s3, 1
    s_cbranch_scc0 mega_rel
mega_reld:
    s_cmp_lg_u32 s50, 8
    s_cbranch_scc1 mega_noearly
    s_mul_i32 s32, s29, 144
    s_lshl_b32 s42, s29, 1
    s_add_u32 s42, s42, s31
    s_mul_i32 s43, s31, 5120
    s_add_u32 s43, s43, 0
    s_cmp_eq_u32 s31, 3
    s_cbranch_scc1 mega_o_skipa
    s_sub_u32 s36, s42, 18
    s_min_u32 s42, s42, s36
    s_mul_i32 s36, s42, 36864
    s_add_u32 s36, s36, s32
    s_add_u32 m0, s43, 0
    s_nop 0
    buffer_load_dwordx4 v16, s[24:27], s36 offen lds
    s_add_u32 m0, s43, 1024
    s_nop 0
    buffer_load_dwordx4 v17, s[24:27], s36 offen lds
    s_add_u32 m0, s43, 2048
    s_nop 0
    buffer_load_dwordx4 v18, s[24:27], s36 offen lds
    s_add_u32 m0, s43, 3072
    s_nop 0
    buffer_load_dwordx4 v19, s[24:27], s36 offen lds
    s_add_u32 m0, s43, 4096
    s_nop 0
    buffer_load_dwordx4 v20, s[24:27], s36 offen lds
    s_add_u32 s42, s42, 3
    s_sub_u32 s36, s42, 18
    s_min_u32 s42, s42, s36
    s_mul_i32 s36, s42, 36864
    s_add_u32 s36, s36, s32
    s_add_u32 m0, s43, 15360
    s_nop 0
    buffer_load_dwordx4 v16, s[24:27], s36 offen lds
    s_add_u32 m0, s43, 16384
    s_nop 0
    buffer_load_dwordx4 v17, s[24:27], s36 offen lds
    s_add_u32 m0, s43, 17408
    s_nop 0
    buffer_load_dwordx4 v18, s[24:27], s36 offen lds
    s_add_u32 m0, s43, 18432
    s_nop 0
    buffer_load_dwordx4 v19, s[24:27], s36 offen lds
    s_add_u32 m0, s43, 19456
    s_nop 0
    buffer_load_dwordx4 v20, s[24:27], s36 offen lds
    s_add_u32 s42, s42, 3
    s_sub_u32 s36, s42, 18
    s_min_u32 s42, s42, s36
    s_mul_i32 s36, s42, 36864
    s_add_u32 s36, s36, s32
    s_add_u32 m0, s43, 30720
    s_nop 0
    buffer_load_dwordx4 v16, s[24:27], s36 offen lds
    s_add_u32 m0, s43, 31744
    s_nop 0
    buffer_load_dwordx4 v17, s[24:27], s36 offen lds
    s_add_u32 m0, s43, 32768
    s_nop 0
    buffer_load_dwordx4 v18, s[24:27], s36 offen lds
    s_add_u32 m0, s43, 33792
    s_nop 0
    buffer_load_dwordx4 v19, s[24:27], s36 offen lds
    s_add_u32 m0, s43, 34816
    s_nop 0
    buffer_load_dwordx4 v20, s[24:27], s36 offen lds
    s_add_u32 s42, s42, 3
    s_sub_u32 s36, s42, 18
    s_min_u32 s42, s42, s36
    s_mul_i32 s36, s42, 36864
    s_add_u32 s36, s36, s32
    s_add_u32 m0, s43, 46080
    s_nop 0
    buffer_load_dwordx4 v16, s[24:27], s36 offen lds
    s_add_u32 m0, s43, 47104
    s_nop 0
    buffer_load_dwordx4 v17, s[24:27], s36 offen lds
    s_add_u32 m0, s43, 48128
    s_nop 0
    buffer_load_dwordx4 v18, s[24:27], s36 offen lds
    s_add_u32 m0, s43, 49152
    s_nop 0
    buffer_load_dwordx4 v19, s[24:27], s36 offen lds
    s_add_u32 m0, s43, 50176
    s_nop 0
    buffer_load_dwordx4 v20, s[24:27], s36 offen lds
    s_add_u32 s42, s42, 3
    s_sub_u32 s36, s42, 18
    s_min_u32 s42, s42, s36
    s_mul_i32 s36, s42, 36864
    s_add_u32 s36, s36, s32
    s_add_u32 m0, s43, 61440
    s_nop 0
    buffer_load_dwordx4 v16, s[24:27], s36 offen lds
    s_add_u32 m0, s43, 62464
    s_nop 0
    buffer_load_dwordx4 v17, s[24:27], s36 offen lds
    s_add_u32 m0, s43, 63488
    s_nop 0
    buffer_load_dwordx4 v18, s[24:27], s36 offen lds
    s_add_u32 m0, s43, 64512
    s_nop 0
    buffer_load_dwordx4 v19, s[24:27], s36 offen lds
    s_add_u32 m0, s43, 65536
    s_nop 0
    buffer_load_dwordx4 v20, s[24:27], s36 offen lds
    s_add_u32 s42, s42, 3
    s_sub_u32 s36, s42, 18
    s_min_u32 s42, s42, s36
    s_mul_i32 s36, s42, 36864
    s_add_u32 s36, s36, s32
    s_add_u32 m0, s43, 76800
    s_nop 0
    buffer_load_dwordx4 v16, s[24:27], s36 offen lds
    s_add_u32 m0, s43, 77824
    s_nop 0
    buffer_load_dwordx4 v17, s[24:27], s36 offen lds
    s_add_u32 m0, s43, 78848
    s_nop 0
    buffer_load_dwordx4 v18, s[24:27], s36 offen lds
    s_add_u32 m0, s43, 79872
    s_nop 0
    buffer_load_dwordx4 v19, s[24:27], s36 offen lds
    s_add_u32 m0, s43, 80896
    s_nop 0
    buffer_load_dwordx4 v20, s[24:27], s36 offen lds
    s_add_u32 s42, s42, 3
mega_o_skipa:
    s_mov_b32 s56, s10
    s_mov_b32 s57, s11
    s_mov_b32 s58, 0x240000
    s_mov_b32 s59, 0x00020000
    s_add_u32 s35, s49, s32
    s_add_u32 m0, s44, 0
    s_nop 0
    buffer_load_dwordx4 v16, s[56:59], s35 offen lds
    s_add_u32 m0, s44, 1024
    s_nop 0
    buffer_load_dwordx4 v17, s[56:59], s35 offen lds
    s_mov_b32 exec_lo, 0xffffffff
    s_mov_b32 exec_hi, 0x0
    s_add_u32 m0, s44, 2048
    s_nop 0
    buffer_load_dwordx4 v18, s[56:59], s35 offen lds
    s_mov_b64 exec, -1
    s_waitcnt vmcnt(0)
    ds_read_b64 v[36:37], v21 offset:0
    ds_read_b64 v[38:39], v21 offset:32
    ds_read_b64 v[40:41], v21 offset:64
    ds_read_b64 v[42:43], v21 offset:96
    ds_read_b64 v[44:45], v21 offset:128
    s_cmp_eq_u32 s31, 3
    s_cbranch_scc1 mega_c_skipa
    v_add_u32 v32, s43, v28
    v_add_u32 v33, s43, v29
    v_add_u32 v34, s43, v11
    s_mov_b32 s36, 6
mega_conva:
    ds_read_b64_tr_b16 v[68:69], v32 offset:0
    ds_read_b64_tr_b16 v[70:71], v33 offset:0
    ds_read_b64_tr_b16 v[72:73], v32 offset:32
    ds_read_b64_tr_b16 v[74:75], v33 offset:32
    ds_read_b64_tr_b16 v[76:77], v32 offset:64
    ds_read_b64_tr_b16 v[78:79], v33 offset:64
    ds_read_b64_tr_b16 v[80:81], v32 offset:96
    ds_read_b64_tr_b16 v[82:83], v33 offset:96
    ds_read_b64_tr_b16 v[84:85], v32 offset:128
    ds_read_b64_tr_b16 v[86:87], v33 offset:128
    v_add_u32 v32, 15360, v32
    v_add_u32 v33, 15360, v33
    s_waitcnt lgkmcnt(0)
    ds_write_b128 v34, v[68:71] offset:0
    ds_write_b128 v34, v[72:75] offset:1024
    ds_write_b128 v34, v[76:79] offset:2048
    ds_write_b128 v34, v[80:83] offset:3072
    ds_write_b128 v34, v[84:87] offset:4096
    v_add_u32 v34, 15360, v34
    s_sub_u32 s36, s36, 1
    s_cmp_lg_u32 s36, 0
    s_cbranch_scc1 mega_conva
mega_c_skipa:
    s_waitcnt lgkmcnt(0)
    v_lshlrev_b32 v48, 16, v36
    v_and_b32 v49, 0xffff0000, v36
    v_lshlrev_b32 v50, 16, v37
    v_and_b32 v51, 0xffff0000, v37
    v_lshlrev_b32 v52, 16, v38
    v_and_b32 v53, 0xffff0000, v38
    v_lshlrev_b32 v54, 16, v39
    v_and_b32 v55, 0xffff0000, v39
    v_lshlrev_b32 v56, 16, v40
    v_and_b32 v57, 0xffff0000, v40
    v_lshlrev_b32 v58, 16, v41
    v_and_b32 v59, 0xffff0000, v41
    v_lshlrev_b32 v60, 16, v42
    v_and_b32 v61, 0xffff0000, v42
    v_lshlrev_b32 v62, 16, v43
    v_and_b32 v63, 0xffff0000, v43
    v_lshlrev_b32 v64, 16, v44
    v_and_b32 v65, 0xffff0000, v44
    v_lshlrev_b32 v66, 16, v45
    v_and_b32 v67, 0xffff0000, v45
mega_noearly:
    s_waitcnt lgkmcnt(0)
    s_barrier
    s_and_b32 s34, s30, 3
    s_lshr_b32 s35, s30, 2
    s_mul_i32 s36, s34, 2304
    s_mul_i32 s37, s35, 768
    s_add_u32 s36, s36, s37
    s_add_u32 s36, s36, 151808
    v_add_u32 v12, s36, v11
    ds_read_b128 v[4:7], v12
    s_lshl_b32 s36, s28, 2
    s_add_u32 s36, s36, s34
    s_mul_i32 s38, s36, 18432
    s_mul_i32 s39, s29, 2304
    s_add_u32 s38, s38, s39
    s_add_u32 s38, s38, s37
    s_add_u32 s38, s38, 2359296
    s_mul_i32 s39, s28, 0
    s_add_u32 s38, s38, s39
    s_lshl_b32 s36, s28, 7
    s_lshl_b32 s39, s29, 3
    s_add_u32 s36, s36, s39
    s_add_u32 s36, s36, 7077888
    s_waitcnt lgkmcnt(0)
    s_mov_b32 exec_lo, 0xffffffff
    s_mov_b32 exec_hi, 0xffff
    buffer_store_dwordx4 v[4:7], v11, s[16:19], s38 offen sc1
    s_mov_b64 exec, -1
    s_waitcnt vmcnt(0)
    v_mov_b32 v12, 163348
    v_mov_b32 v13, 1
    s_mov_b32 exec_lo, 0x1
    s_mov_b32 exec_hi, 0x0
    ds_add_rtn_u32 v14, v12, v13
    s_mov_b64 exec, -1
    s_waitcnt lgkmcnt(0)
    v_readfirstlane_b32 s3, v14
    s_nop 0
    s_cmp_lg_u32 s3, 11
    s_cbranch_scc1 mega_arr_ob
    v_mov_b32 v12, 0
    v_mov_b32 v14, s66
    v_mov_b32 v15, s67
    s_mov_b32 exec_lo, 0x1
    s_mov_b32 exec_hi, 0x0
    buffer_store_dwordx2 v[14:15], v12, s[16:19], s36 offen sc1
    s_mov_b64 exec, -1
mega_arr_ob:
    s_cmp_eq_u32 s50, 8
    s_cbranch_scc1 mega_nolate
    s_mul_i32 s32, s29, 144
    s_lshl_b32 s42, s29, 1
    s_add_u32 s42, s42, s31
    s_mul_i32 s43, s31, 5120
    s_add_u32 s43, s43, 0
    s_cmp_eq_u32 s31, 3
    s_cbranch_scc1 mega_o_skipb
    s_sub_u32 s36, s42, 18
    s_min_u32 s42, s42, s36
    s_mul_i32 s36, s42, 36864
    s_add_u32 s36, s36, s32
    s_add_u32 m0, s43, 0
    s_nop 0
    buffer_load_dwordx4 v16, s[24:27], s36 offen lds
    s_add_u32 m0, s43, 1024
    s_nop 0
    buffer_load_dwordx4 v17, s[24:27], s36 offen lds
    s_add_u32 m0, s43, 2048
    s_nop 0
    buffer_load_dwordx4 v18, s[24:27], s36 offen lds
    s_add_u32 m0, s43, 3072
    s_nop 0
    buffer_load_dwordx4 v19, s[24:27], s36 offen lds
    s_add_u32 m0, s43, 4096
    s_nop 0
    buffer_load_dwordx4 v20, s[24:27], s36 offen lds
    s_add_u32 s42, s42, 3
    s_sub_u32 s36, s42, 18
    s_min_u32 s42, s42, s36
    s_mul_i32 s36, s42, 36864
    s_add_u32 s36, s36, s32
    s_add_u32 m0, s43, 15360
    s_nop 0
    buffer_load_dwordx4 v16, s[24:27], s36 offen lds
    s_add_u32 m0, s43, 16384
    s_nop 0
    buffer_load_dwordx4 v17, s[24:27], s36 offen lds
    s_add_u32 m0, s43, 17408
    s_nop 0
    buffer_load_dwordx4 v18, s[24:27], s36 offen lds
    s_add_u32 m0, s43, 18432
    s_nop 0
    buffer_load_dwordx4 v19, s[24:27], s36 offen lds
    s_add_u32 m0, s43, 19456
    s_nop 0
    buffer_load_dwordx4 v20, s[24:27], s36 offen lds
    s_add_u32 s42, s42, 3
    s_sub_u32 s36, s42, 18
    s_min_u32 s42, s42, s36
    s_mul_i32 s36, s42, 36864
    s_add_u32 s36, s36, s32
    s_add_u32 m0, s43, 30720
    s_nop 0
    buffer_load_dwordx4 v16, s[24:27], s36 offen lds
    s_add_u32 m0, s43, 31744
    s_nop 0
    buffer_load_dwordx4 v17, s[24:27], s36 offen lds
    s_add_u32 m0, s43, 32768
    s_nop 0
    buffer_load_dwordx4 v18, s[24:27], s36 offen lds
    s_add_u32 m0, s43, 33792
    s_nop 0
    buffer_load_dwordx4 v19, s[24:27], s36 offen lds
    s_add_u32 m0, s43, 34816
    s_nop 0
    buffer_load_dwordx4 v20, s[24:27], s36 offen lds
    s_add_u32 s42, s42, 3
    s_sub_u32 s36, s42, 18
    s_min_u32 s42, s42, s36
    s_mul_i32 s36, s42, 36864
    s_add_u32 s36, s36, s32
    s_add_u32 m0, s43, 46080
    s_nop 0
    buffer_load_dwordx4 v16, s[24:27], s36 offen lds
    s_add_u32 m0, s43, 47104
    s_nop 0
    buffer_load_dwordx4 v17, s[24:27], s36 offen lds
    s_add_u32 m0, s43, 48128
    s_nop 0
    buffer_load_dwordx4 v18, s[24:27], s36 offen lds
    s_add_u32 m0, s43, 49152
    s_nop 0
    buffer_load_dwordx4 v19, s[24:27], s36 offen lds
    s_add_u32 m0, s43, 50176
    s_nop 0
    buffer_load_dwordx4 v20, s[24:27], s36 offen lds
    s_add_u32 s42, s42, 3
    s_sub_u32 s36, s42, 18
    s_min_u32 s42, s42, s36
    s_mul_i32 s36, s42, 36864
    s_add_u32 s36, s36, s32
    s_add_u32 m0, s43, 61440
    s_nop 0
    buffer_load_dwordx4 v16, s[24:27], s36 offen lds
    s_add_u32 m0, s43, 62464
    s_nop 0
    buffer_load_dwordx4 v17, s[24:27], s36 offen lds
    s_add_u32 m0, s43, 63488
    s_nop 0
    buffer_load_dwordx4 v18, s[24:27], s36 offen lds
    s_add_u32 m0, s43, 64512
    s_nop 0
    buffer_load_dwordx4 v19, s[24:27], s36 offen lds
    s_add_u32 m0, s43, 65536
    s_nop 0
    buffer_load_dwordx4 v20, s[24:27], s36 offen lds
    s_add_u32 s42, s42, 3
    s_sub_u32 s36, s42, 18
    s_min_u32 s42, s42, s36
    s_mul_i32 s36, s42, 36864
    s_add_u32 s36, s36, s32
    s_add_u32 m0, s43, 76800
    s_nop 0
    buffer_load_dwordx4 v16, s[24:27], s36 offen lds
    s_add_u32 m0, s43, 77824
    s_nop 0
    buffer_load_dwordx4 v17, s[24:27], s36 offen lds
    s_add_u32 m0, s43, 78848
    s_nop 0
    buffer_load_dwordx4 v18, s[24:27], s36 offen lds
    s_add_u32 m0, s43, 79872
    s_nop 0
    buffer_load_dwordx4 v19, s[24:27], s36 offen lds
    s_add_u32 m0, s43, 80896
    s_nop 0
    buffer_load_dwordx4 v20, s[24:27], s36 offen lds
    s_add_u32 s42, s42, 3
mega_o_skipb:
    s_mov_b32 s56, s10
    s_mov_b32 s57, s11
    s_mov_b32 s58, 0x240000
    s_mov_b32 s59, 0x00020000
    s_add_u32 s35, s49, s32
    s_add_u32 m0, s44, 0
    s_nop 0
    buffer_load_dwordx4 v16, s[56:59], s35 offen lds
    s_add_u32 m0, s44, 1024
    s_nop 0
    buffer_load_dwordx4 v17, s[56:59], s35 offen lds
    s_mov_b32 exec_lo, 0xffffffff
    s_mov_b32 exec_hi, 0x0
    s_add_u32 m0, s44, 2048
    s_nop 0
    buffer_load_dwordx4 v18, s[56:59], s35 offen lds
    s_mov_b64 exec, -1
    s_waitcnt vmcnt(0)
    ds_read_b64 v[36:37], v21 offset:0
    ds_read_b64 v[38:39], v21 offset:32
    ds_read_b64 v[40:41], v21 offset:64
    ds_read_b64 v[42:43], v21 offset:96
    ds_read_b64 v[44:45], v21 offset:128
    s_cmp_eq_u32 s31, 3
    s_cbranch_scc1 mega_c_skipb
    v_add_u32 v32, s43, v28
    v_add_u32 v33, s43, v29
    v_add_u32 v34, s43, v11
    s_mov_b32 s36, 6
mega_convb:
    ds_read_b64_tr_b16 v[68:69], v32 offset:0
    ds_read_b64_tr_b16 v[70:71], v33 offset:0
    ds_read_b64_tr_b16 v[72:73], v32 offset:32
    ds_read_b64_tr_b16 v[74:75], v33 offset:32
    ds_read_b64_tr_b16 v[76:77], v32 offset:64
    ds_read_b64_tr_b16 v[78:79], v33 offset:64
    ds_read_b64_tr_b16 v[80:81], v32 offset:96
    ds_read_b64_tr_b16 v[82:83], v33 offset:96
    ds_read_b64_tr_b16 v[84:85], v32 offset:128
    ds_read_b64_tr_b16 v[86:87], v33 offset:128
    v_add_u32 v32, 15360, v32
    v_add_u32 v33, 15360, v33
    s_waitcnt lgkmcnt(0)
    ds_write_b128 v34, v[68:71] offset:0
    ds_write_b128 v34, v[72:75] offset:1024
    ds_write_b128 v34, v[76:79] offset:2048
    ds_write_b128 v34, v[80:83] offset:3072
    ds_write_b128 v34, v[84:87] offset:4096
    v_add_u32 v34, 15360, v34
    s_sub_u32 s36, s36, 1
    s_cmp_lg_u32 s36, 0
    s_cbranch_scc1 mega_convb
mega_c_skipb:
    s_waitcnt lgkmcnt(0)
    v_lshlrev_b32 v48, 16, v36
    v_and_b32 v49, 0xffff0000, v36
    v_lshlrev_b32 v50, 16, v37
    v_and_b32 v51, 0xffff0000, v37
    v_lshlrev_b32 v52, 16, v38
    v_and_b32 v53, 0xffff0000, v38
    v_lshlrev_b32 v54, 16, v39
    v_and_b32 v55, 0xffff0000, v39
    v_lshlrev_b32 v56, 16, v40
    v_and_b32 v57, 0xffff0000, v40
    v_lshlrev_b32 v58, 16, v41
    v_and_b32 v59, 0xffff0000, v41
    v_lshlrev_b32 v60, 16, v42
    v_and_b32 v61, 0xffff0000, v42
    v_lshlrev_b32 v62, 16, v43
    v_and_b32 v63, 0xffff0000, v43
    v_lshlrev_b32 v64, 16, v44
    v_and_b32 v65, 0xffff0000, v44
    v_lshlrev_b32 v66, 16, v45
    v_and_b32 v67, 0xffff0000, v45
mega_nolate:
    s_lshl_b32 s34, s28, 7
    s_add_u32 s34, s34, 7077888
    s_cmp_lg_u32 s31, 0
    s_cbranch_scc1 mega_polld_o
    v_mov_b32 v12, 163348
    s_mov_b32 s3, 524288
mega_lw_owno:
    ds_read_b32 v13, v12
    s_waitcnt lgkmcnt(0)
    v_readfirstlane_b32 s39, v13
    s_nop 0
    s_cmp_ge_u32 s39, 12
    s_cbranch_scc1 mega_lwd_owno
    s_sleep 1
    s_sub_u32 s3, s3, 1
    s_cbranch_scc0 mega_lw_owno
mega_lwd_owno:
    s_mov_b32 s3, 65536
mega_poll_o:
    s_sleep 2
    buffer_load_dwordx2 v[32:33], v23, s[16:19], s34 offen sc1
    s_waitcnt vmcnt(0)
    v_cmp_eq_u64 vcc, s[66:67], v[32:33]
    s_nop 0
    s_cmp_eq_u64 vcc, -1
    s_cbranch_scc1 mega_polld_o
    s_sub_u32 s3, s3, 1
    s_cbranch_scc0 mega_poll_o
mega_polld_o:
    v_mov_b32 v12, 163440
    v_mov_b32 v13, 1
    s_mov_b32 exec_lo, 0x1
    s_mov_b32 exec_hi, 0x0
    ds_add_u32 v12, v13
    s_mov_b64 exec, -1
    v_mov_b32 v12, 163440
    s_mov_b32 s3, 524288
mega_lw_ord:
    ds_read_b32 v13, v12
    s_waitcnt lgkmcnt(0)
    v_readfirstlane_b32 s39, v13
    s_nop 0
    s_cmp_ge_u32 s39, 4
    s_cbranch_scc1 mega_lwd_ord
    s_sleep 1
    s_sub_u32 s3, s3, 1
    s_cbranch_scc0 mega_lw_ord
mega_lwd_ord:
    buffer_load_dwordx4 v[96:99], v24, s[16:19], s51 offen sc1
    s_add_u32 s51, s51, 1024
    s_cmp_eq_u32 s51, 18432
    s_cselect_b32 s51, 0, s51
    buffer_load_dwordx4 v[100:103], v24, s[16:19], s51 offen sc1
    s_add_u32 s51, s51, 1024
    s_cmp_eq_u32 s51, 18432
    s_cselect_b32 s51, 0, s51
    buffer_load_dwordx4 v[104:107], v24, s[16:19], s51 offen sc1
    s_add_u32 s51, s51, 1024
    s_cmp_eq_u32 s51, 18432
    s_cselect_b32 s51, 0, s51
    buffer_load_dwordx4 v[108:111], v24, s[16:19], s51 offen sc1
    s_add_u32 s51, s51, 1024
    s_cmp_eq_u32 s51, 18432
    s_cselect_b32 s51, 0, s51
    buffer_load_dwordx4 v[112:115], v24, s[16:19], s51 offen sc1
    s_add_u32 s51, s51, 1024
    s_cmp_eq_u32 s51, 18432
    s_cselect_b32 s51, 0, s51
    buffer_load_dwordx4 v[116:119], v24, s[16:19], s51 offen sc1
    s_add_u32 s51, s51, 1024
    s_cmp_eq_u32 s51, 18432
    s_cselect_b32 s51, 0, s51
    buffer_load_dwordx4 v[120:123], v24, s[16:19], s51 offen sc1
    s_add_u32 s51, s51, 1024
    s_cmp_eq_u32 s51, 18432
    s_cselect_b32 s51, 0, s51
    buffer_load_dwordx4 v[124:127], v24, s[16:19], s51 offen sc1
    s_add_u32 s51, s51, 1024
    s_cmp_eq_u32 s51, 18432
    s_cselect_b32 s51, 0, s51
    buffer_load_dwordx4 v[128:131], v24, s[16:19], s51 offen sc1
    s_add_u32 s51, s51, 1024
    s_cmp_eq_u32 s51, 18432
    s_cselect_b32 s51, 0, s51
    buffer_load_dwordx4 v[132:135], v24, s[16:19], s51 offen sc1
    s_add_u32 s51, s51, 1024
    s_cmp_eq_u32 s51, 18432
    s_cselect_b32 s51, 0, s51
    buffer_load_dwordx4 v[136:139], v24, s[16:19], s51 offen sc1
    s_add_u32 s51, s51, 1024
    s_cmp_eq_u32 s51, 18432
    s_cselect_b32 s51, 0, s51
    buffer_load_dwordx4 v[140:143], v24, s[16:19], s51 offen sc1
    s_add_u32 s51, s51, 1024
    s_cmp_eq_u32 s51, 18432
    s_cselect_b32 s51, 0, s51
    buffer_load_dwordx4 v[144:147], v24, s[16:19], s51 offen sc1
    s_add_u32 s51, s51, 1024
    s_cmp_eq_u32 s51, 18432
    s_cselect_b32 s51, 0, s51
    buffer_load_dwordx4 v[148:151], v24, s[16:19], s51 offen sc1
    s_add_u32 s51, s51, 1024
    s_cmp_eq_u32 s51, 18432
    s_cselect_b32 s51, 0, s51
    buffer_load_dwordx4 v[152:155], v24, s[16:19], s51 offen sc1
    s_add_u32 s51, s51, 1024
    s_cmp_eq_u32 s51, 18432
    s_cselect_b32 s51, 0, s51
    buffer_load_dwordx4 v[156:159], v24, s[16:19], s51 offen sc1
    s_add_u32 s51, s51, 1024
    s_cmp_eq_u32 s51, 18432
    s_cselect_b32 s51, 0, s51
    buffer_load_dwordx4 v[160:163], v24, s[16:19], s51 offen sc1
    s_add_u32 s51, s51, 1024
    s_cmp_eq_u32 s51, 18432
    s_cselect_b32 s51, 0, s51
    buffer_load_dwordx4 v[164:167], v24, s[16:19], s51 offen sc1
    s_add_u32 s51, s51, 1024
    s_cmp_eq_u32 s51, 18432
    s_cselect_b32 s51, 0, s51
    ds_read_b128 v[68:71], v11 offset:0
    ds_read_b128 v[72:75], v11 offset:1024
    ds_read_b128 v[76:79], v11 offset:2048
    ds_read_b128 v[80:83], v11 offset:3072
    ds_read_b128 v[84:87], v11 offset:4096
    ds_read_b128 v[88:91], v11 offset:5120
    ds_read_b128 v[92:95], v11 offset:6144
    s_mul_i32 s34, s30, 110592
    s_mul_i32 s35, s46, 1327104
    s_add_u32 s34, s34, s35
    s_add_u32 s34, s34, 7602176
    s_add_u32 s20, s12, s34
    s_addc_u32 s21, s13, 0
    s_mov_b32 s22, 110592
    s_mov_b32 s23, 0x00020000
    s_waitcnt lgkmcnt(6) vmcnt(17)
    v_mfma_f32_16x16x32_bf16 v[48:51], v[68:71], v[96:99], v[48:51]
    ds_read_b128 v[68:71], v11 offset:7168
    s_waitcnt lgkmcnt(6)
    v_mfma_f32_16x16x32_bf16 v[52:55], v[72:75], v[96:99], v[52:55]
    ds_read_b128 v[72:75], v11 offset:8192
    s_waitcnt lgkmcnt(6)
    v_mfma_f32_16x16x32_bf16 v[56:59], v[76:79], v[96:99], v[56:59]
    ds_read_b128 v[76:79], v11 offset:9216
    s_waitcnt lgkmcnt(6)
    v_mfma_f32_16x16x32_bf16 v[60:63], v[80:83], v[96:99], v[60:63]
    ds_read_b128 v[80:83], v11 offset:10240
    s_waitcnt lgkmcnt(6)
    v_mfma_f32_16x16x32_bf16 v[64:67], v[84:87], v[96:99], v[64:67]
    ds_read_b128 v[84:87], v11 offset:11264
    s_waitcnt lgkmcnt(6) vmcnt(16)
    v_mfma_f32_16x16x32_bf16 v[48:51], v[88:91], v[100:103], v[48:51]
    ds_read_b128 v[88:91], v11 offset:12288
    s_waitcnt lgkmcnt(6)
    v_mfma_f32_16x16x32_bf16 v[52:55], v[92:95], v[100:103], v[52:55]
    ds_read_b128 v[92:95], v11 offset:13312
    s_waitcnt lgkmcnt(6)
    v_mfma_f32_16x16x32_bf16 v[56:59], v[68:71], v[100:103], v[56:59]
    ds_read_b128 v[68:71], v11 offset:14336
    s_waitcnt lgkmcnt(6)
    v_mfma_f32_16x16x32_bf16 v[60:63], v[72:75], v[100:103], v[60:63]
    ds_read_b128 v[72:75], v11 offset:15360
    s_waitcnt lgkmcnt(6)
    v_mfma_f32_16x16x32_bf16 v[64:67], v[76:79], v[100:103], v[64:67]
    ds_read_b128 v[76:79], v11 offset:16384
    s_waitcnt lgkmcnt(6) vmcnt(15)
    v_mfma_f32_16x16x32_bf16 v[48:51], v[80:83], v[104:107], v[48:51]
    ds_read_b128 v[80:83], v11 offset:17408
    s_waitcnt lgkmcnt(6)
    v_mfma_f32_16x16x32_bf16 v[52:55], v[84:87], v[104:107], v[52:55]
    ds_read_b128 v[84:87], v11 offset:18432
    s_waitcnt lgkmcnt(6)
    v_mfma_f32_16x16x32_bf16 v[56:59], v[88:91], v[104:107], v[56:59]
    ds_read_b128 v[88:91], v11 offset:19456
    s_waitcnt lgkmcnt(6)
    v_mfma_f32_16x16x32_bf16 v[60:63], v[92:95], v[104:107], v[60:63]
    ds_read_b128 v[92:95], v11 offset:20480
    s_waitcnt lgkmcnt(6)
    v_mfma_f32_16x16x32_bf16 v[64:67], v[68:71], v[104:107], v[64:67]
    ds_read_b128 v[68:71], v11 offset:21504
    s_movk_i32 s53, 15360
    buffer_load_dwordx4 v[96:99], v11, s[20:23], s53 offen offset:0 sc1
    buffer_load_dwordx4 v[100:103], v11, s[20:23], s53 offen offset:1024 sc1
    buffer_load_dwordx4 v[104:107], v11, s[20:23], s53 offen offset:2048 sc1
    s_waitcnt lgkmcnt(6) vmcnt(17)
    v_mfma_f32_16x16x32_bf16 v[48:51], v[72:75], v[108:111], v[48:51]
    ds_read_b128 v[72:75], v11 offset:22528
    s_waitcnt lgkmcnt(6)
    v_mfma_f32_16x16x32_bf16 v[52:55], v[76:79], v[108:111], v[52:55]
    ds_read_b128 v[76:79], v11 offset:23552
    s_waitcnt lgkmcnt(6)
    v_mfma_f32_16x16x32_bf16 v[56:59], v[80:83], v[108:111], v[56:59]
    ds_read_b128 v[80:83], v11 offset:24576
    s_waitcnt lgkmcnt(6)
    v_mfma_f32_16x16x32_bf16 v[60:63], v[84:87], v[108:111], v[60:63]
    ds_read_b128 v[84:87], v11 offset:25600
    s_waitcnt lgkmcnt(6)
    v_mfma_f32_16x16x32_bf16 v[64:67], v[88:91], v[108:111], v[64:67]
    ds_read_b128 v[88:91], v11 offset:26624
    s_waitcnt lgkmcnt(6) vmcnt(16)
    v_mfma_f32_16x16x32_bf16 v[48:51], v[92:95], v[112:115], v[48:51]
    ds_read_b128 v[92:95], v11 offset:27648
    s_waitcnt lgkmcnt(6)
    v_mfma_f32_16x16x32_bf16 v[52:55], v[68:71], v[112:115], v[52:55]
    ds_read_b128 v[68:71], v11 offset:28672
    s_waitcnt lgkmcnt(6)
    v_mfma_f32_16x16x32_bf16 v[56:59], v[72:75], v[112:115], v[56:59]
    ds_read_b128 v[72:75], v11 offset:29696
    s_waitcnt lgkmcnt(6)
    v_mfma_f32_16x16x32_bf16 v[60:63], v[76:79], v[112:115], v[60:63]
    ds_read_b128 v[76:79], v11 offset:30720
    s_waitcnt lgkmcnt(6)
    v_mfma_f32_16x16x32_bf16 v[64:67], v[80:83], v[112:115], v[64:67]
    ds_read_b128 v[80:83], v11 offset:31744
    s_waitcnt lgkmcnt(6) vmcnt(15)
    v_mfma_f32_16x16x32_bf16 v[48:51], v[84:87], v[116:119], v[48:51]
    ds_read_b128 v[84:87], v11 offset:32768
    s_waitcnt lgkmcnt(6)
    v_mfma_f32_16x16x32_bf16 v[52:55], v[88:91], v[116:119], v[52:55]
    ds_read_b128 v[88:91], v11 offset:33792
    s_waitcnt lgkmcnt(6)
    v_mfma_f32_16x16x32_bf16 v[56:59], v[92:95], v[116:119], v[56:59]
    ds_read_b128 v[92:95], v11 offset:34816
    s_waitcnt lgkmcnt(6)
    v_mfma_f32_16x16x32_bf16 v[60:63], v[68:71], v[116:119], v[60:63]
    ds_read_b128 v[68:71], v11 offset:35840
    s_waitcnt lgkmcnt(6)
    v_mfma_f32_16x16x32_bf16 v[64:67], v[72:75], v[116:119], v[64:67]
    ds_read_b128 v[72:75], v11 offset:36864
    s_movk_i32 s53, 0
    buffer_load_dwordx4 v[108:111], v11, s[20:23], s53 offen offset:0 sc1
    buffer_load_dwordx4 v[112:115], v11, s[20:23], s53 offen offset:1024 sc1
    buffer_load_dwordx4 v[116:119], v11, s[20:23], s53 offen offset:2048 sc1
    s_waitcnt lgkmcnt(6) vmcnt(17)
    v_mfma_f32_16x16x32_bf16 v[48:51], v[76:79], v[120:123], v[48:51]
    ds_read_b128 v[76:79], v11 offset:37888
    s_waitcnt lgkmcnt(6)
    v_mfma_f32_16x16x32_bf16 v[52:55], v[80:83], v[120:123], v[52:55]
    ds_read_b128 v[80:83], v11 offset:38912
    s_waitcnt lgkmcnt(6)
    v_mfma_f32_16x16x32_bf16 v[56:59], v[84:87], v[120:123], v[56:59]
    ds_read_b128 v[84:87], v11 offset:39936
    s_waitcnt lgkmcnt(6)
    v_mfma_f32_16x16x32_bf16 v[60:63], v[88:91], v[120:123], v[60:63]
    ds_read_b128 v[88:91], v11 offset:40960
    s_waitcnt lgkmcnt(6)
    v_mfma_f32_16x16x32_bf16 v[64:67], v[92:95], v[120:123], v[64:67]
    ds_read_b128 v[92:95], v11 offset:41984
    s_waitcnt lgkmcnt(6) vmcnt(16)
    v_mfma_f32_16x16x32_bf16 v[48:51], v[68:71], v[124:127], v[48:51]
    ds_read_b128 v[68:71], v11 offset:43008
    s_waitcnt lgkmcnt(6)
    v_mfma_f32_16x16x32_bf16 v[52:55], v[72:75], v[124:127], v[52:55]
    ds_read_b128 v[72:75], v11 offset:44032
    s_waitcnt lgkmcnt(6)
    v_mfma_f32_16x16x32_bf16 v[56:59], v[76:79], v[124:127], v[56:59]
    ds_read_b128 v[76:79], v11 offset:45056
    s_waitcnt lgkmcnt(6)
    v_mfma_f32_16x16x32_bf16 v[60:63], v[80:83], v[124:127], v[60:63]
    ds_read_b128 v[80:83], v11 offset:46080
    s_waitcnt lgkmcnt(6)
    v_mfma_f32_16x16x32_bf16 v[64:67], v[84:87], v[124:127], v[64:67]
    ds_read_b128 v[84:87], v11 offset:47104
    s_waitcnt lgkmcnt(6) vmcnt(15)
    v_mfma_f32_16x16x32_bf16 v[48:51], v[88:91], v[128:131], v[48:51]
    ds_read_b128 v[88:91], v11 offset:48128
    s_waitcnt lgkmcnt(6)
    v_mfma_f32_16x16x32_bf16 v[52:55], v[92:95], v[128:131], v[52:55]
    ds_read_b128 v[92:95], v11 offset:49152
    s_waitcnt lgkmcnt(6)
    v_mfma_f32_16x16x32_bf16 v[56:59], v[68:71], v[128:131], v[56:59]
    ds_read_b128 v[68:71], v11 offset:50176
    s_waitcnt lgkmcnt(6)
    v_mfma_f32_16x16x32_bf16 v[60:63], v[72:75], v[128:131], v[60:63]
    ds_read_b128 v[72:75], v11 offset:51200
    s_waitcnt lgkmcnt(6)
    v_mfma_f32_16x16x32_bf16 v[64:67], v[76:79], v[128:131], v[64:67]
    ds_read_b128 v[76:79], v11 offset:52224
    s_movk_i32 s53, 3072
    buffer_load_dwordx4 v[120:123], v11, s[20:23], s53 offen offset:0 sc1
    buffer_load_dwordx4 v[124:127], v11, s[20:23], s53 offen offset:1024 sc1
    buffer_load_dwordx4 v[128:131], v11, s[20:23], s53 offen offset:2048 sc1
    s_waitcnt lgkmcnt(6) vmcnt(17)
    v_mfma_f32_16x16x32_bf16 v[48:51], v[80:83], v[132:135], v[48:51]
    ds_read_b128 v[80:83], v11 offset:53248
    s_waitcnt lgkmcnt(6)
    v_mfma_f32_16x16x32_bf16 v[52:55], v[84:87], v[132:135], v[52:55]
    ds_read_b128 v[84:87], v11 offset:54272
    s_waitcnt lgkmcnt(6)
    v_mfma_f32_16x16x32_bf16 v[56:59], v[88:91], v[132:135], v[56:59]
    ds_read_b128 v[88:91], v11 offset:55296
    s_waitcnt lgkmcnt(6)
    v_mfma_f32_16x16x32_bf16 v[60:63], v[92:95], v[132:135], v[60:63]
    ds_read_b128 v[92:95], v11 offset:56320
    s_waitcnt lgkmcnt(6)
    v_mfma_f32_16x16x32_bf16 v[64:67], v[68:71], v[132:135], v[64:67]
    ds_read_b128 v[68:71], v11 offset:57344
    s_waitcnt lgkmcnt(6) vmcnt(16)
    v_mfma_f32_16x16x32_bf16 v[48:51], v[72:75], v[136:139], v[48:51]
    ds_read_b128 v[72:75], v11 offset:58368
    s_waitcnt lgkmcnt(6)
    v_mfma_f32_16x16x32_bf16 v[52:55], v[76:79], v[136:139], v[52:55]
    ds_read_b128 v[76:79], v11 offset:59392
    s_waitcnt lgkmcnt(6)
    v_mfma_f32_16x16x32_bf16 v[56:59], v[80:83], v[136:139], v[56:59]
    ds_read_b128 v[80:83], v11 offset:60416
    s_waitcnt lgkmcnt(6)
    v_mfma_f32_16x16x32_bf16 v[60:63], v[84:87], v[136:139], v[60:63]
    ds_read_b128 v[84:87], v30 offset:0
    s_waitcnt lgkmcnt(6)
    v_mfma_f32_16x16x32_bf16 v[64:67], v[88:91], v[136:139], v[64:67]
    ds_read_b128 v[88:91], v30 offset:1024
    s_waitcnt lgkmcnt(6) vmcnt(15)
    v_mfma_f32_16x16x32_bf16 v[48:51], v[92:95], v[140:143], v[48:51]
    ds_read_b128 v[92:95], v30 offset:2048
    s_waitcnt lgkmcnt(6)
    v_mfma_f32_16x16x32_bf16 v[52:55], v[68:71], v[140:143], v[52:55]
    ds_read_b128 v[68:71], v30 offset:3072
    s_waitcnt lgkmcnt(6)
    v_mfma_f32_16x16x32_bf16 v[56:59], v[72:75], v[140:143], v[56:59]
    ds_read_b128 v[72:75], v30 offset:4096
    s_waitcnt lgkmcnt(6)
    v_mfma_f32_16x16x32_bf16 v[60:63], v[76:79], v[140:143], v[60:63]
    ds_read_b128 v[76:79], v30 offset:5120
    s_waitcnt lgkmcnt(6)
    v_mfma_f32_16x16x32_bf16 v[64:67], v[80:83], v[140:143], v[64:67]
    ds_read_b128 v[80:83], v30 offset:6144
    s_movk_i32 s53, 6144
    buffer_load_dwordx4 v[132:135], v11, s[20:23], s53 offen offset:0 sc1
    buffer_load_dwordx4 v[136:139], v11, s[20:23], s53 offen offset:1024 sc1
    buffer_load_dwordx4 v[140:143], v11, s[20:23], s53 offen offset:2048 sc1
    s_waitcnt lgkmcnt(6) vmcnt(17)
    v_mfma_f32_16x16x32_bf16 v[48:51], v[84:87], v[144:147], v[48:51]
    ds_read_b128 v[84:87], v30 offset:7168
    s_waitcnt lgkmcnt(6)
    v_mfma_f32_16x16x32_bf16 v[52:55], v[88:91], v[144:147], v[52:55]
    ds_read_b128 v[88:91], v30 offset:8192
    s_waitcnt lgkmcnt(6)
    v_mfma_f32_16x16x32_bf16 v[56:59], v[92:95], v[144:147], v[56:59]
    ds_read_b128 v[92:95], v30 offset:9216
    s_waitcnt lgkmcnt(6)
    v_mfma_f32_16x16x32_bf16 v[60:63], v[68:71], v[144:147], v[60:63]
    ds_read_b128 v[68:71], v30 offset:10240
    s_waitcnt lgkmcnt(6)
    v_mfma_f32_16x16x32_bf16 v[64:67], v[72:75], v[144:147], v[64:67]
    ds_read_b128 v[72:75], v30 offset:11264
    s_waitcnt lgkmcnt(6) vmcnt(16)
    v_mfma_f32_16x16x32_bf16 v[48:51], v[76:79], v[148:151], v[48:51]
    ds_read_b128 v[76:79], v30 offset:12288
    s_waitcnt lgkmcnt(6)
    v_mfma_f32_16x16x32_bf16 v[52:55], v[80:83], v[148:151], v[52:55]
    ds_read_b128 v[80:83], v30 offset:13312
    s_waitcnt lgkmcnt(6)
    v_mfma_f32_16x16x32_bf16 v[56:59], v[84:87], v[148:151], v[56:59]
    ds_read_b128 v[84:87], v30 offset:14336
    s_waitcnt lgkmcnt(6)
    v_mfma_f32_16x16x32_bf16 v[60:63], v[88:91], v[148:151], v[60:63]
    ds_read_b128 v[88:91], v30 offset:15360
    s_waitcnt lgkmcnt(6)
    v_mfma_f32_16x16x32_bf16 v[64:67], v[92:95], v[148:151], v[64:67]
    ds_read_b128 v[92:95], v30 offset:16384
    s_waitcnt lgkmcnt(6) vmcnt(15)
    v_mfma_f32_16x16x32_bf16 v[48:51], v[68:71], v[152:155], v[48:51]
    ds_read_b128 v[68:71], v30 offset:17408
    s_waitcnt lgkmcnt(6)
    v_mfma_f32_16x16x32_bf16 v[52:55], v[72:75], v[152:155], v[52:55]
    ds_read_b128 v[72:75], v30 offset:18432
    s_waitcnt lgkmcnt(6)
    v_mfma_f32_16x16x32_bf16 v[56:59], v[76:79], v[152:155], v[56:59]
    ds_read_b128 v[76:79], v30 offset:19456
    s_waitcnt lgkmcnt(6)
    v_mfma_f32_16x16x32_bf16 v[60:63], v[80:83], v[152:155], v[60:63]
    ds_read_b128 v[80:83], v30 offset:20480
    s_waitcnt lgkmcnt(6)
    v_mfma_f32_16x16x32_bf16 v[64:67], v[84:87], v[152:155], v[64:67]
    ds_read_b128 v[84:87], v30 offset:21504
    s_movk_i32 s53, 9216
    buffer_load_dwordx4 v[144:147], v11, s[20:23], s53 offen offset:0 sc1
    buffer_load_dwordx4 v[148:151], v11, s[20:23], s53 offen offset:1024 sc1
    buffer_load_dwordx4 v[152:155], v11, s[20:23], s53 offen offset:2048 sc1
    s_waitcnt lgkmcnt(6) vmcnt(17)
    v_mfma_f32_16x16x32_bf16 v[48:51], v[88:91], v[156:159], v[48:51]
    ds_read_b128 v[88:91], v30 offset:22528
    s_waitcnt lgkmcnt(6)
    v_mfma_f32_16x16x32_bf16 v[52:55], v[92:95], v[156:159], v[52:55]
    ds_read_b128 v[92:95], v30 offset:23552
    s_waitcnt lgkmcnt(6)
    v_mfma_f32_16x16x32_bf16 v[56:59], v[68:71], v[156:159], v[56:59]
    ds_read_b128 v[68:71], v30 offset:24576
    s_waitcnt lgkmcnt(6)
    v_mfma_f32_16x16x32_bf16 v[60:63], v[72:75], v[156:159], v[60:63]
    ds_read_b128 v[72:75], v30 offset:25600
    s_waitcnt lgkmcnt(6)
    v_mfma_f32_16x16x32_bf16 v[64:67], v[76:79], v[156:159], v[64:67]
    ds_read_b128 v[76:79], v30 offset:26624
    s_waitcnt lgkmcnt(6) vmcnt(16)
    v_mfma_f32_16x16x32_bf16 v[48:51], v[80:83], v[160:163], v[48:51]
    ds_read_b128 v[80:83], v30 offset:27648
    s_waitcnt lgkmcnt(6)
    v_mfma_f32_16x16x32_bf16 v[52:55], v[84:87], v[160:163], v[52:55]
    ds_read_b128 v[84:87], v30 offset:28672
    s_waitcnt lgkmcnt(6)
    v_mfma_f32_16x16x32_bf16 v[56:59], v[88:91], v[160:163], v[56:59]
    ds_read_b128 v[88:91], v30 offset:29696
    s_waitcnt lgkmcnt(6)
    v_mfma_f32_16x16x32_bf16 v[60:63], v[92:95], v[160:163], v[60:63]
    s_waitcnt lgkmcnt(5)
    v_mfma_f32_16x16x32_bf16 v[64:67], v[68:71], v[160:163], v[64:67]
    s_waitcnt lgkmcnt(4) vmcnt(15)
    v_mfma_f32_16x16x32_bf16 v[48:51], v[72:75], v[164:167], v[48:51]
    s_waitcnt lgkmcnt(3)
    v_mfma_f32_16x16x32_bf16 v[52:55], v[76:79], v[164:167], v[52:55]
    s_waitcnt lgkmcnt(2)
    v_mfma_f32_16x16x32_bf16 v[56:59], v[80:83], v[164:167], v[56:59]
    s_waitcnt lgkmcnt(1)
    v_mfma_f32_16x16x32_bf16 v[60:63], v[84:87], v[164:167], v[60:63]
    s_waitcnt lgkmcnt(0)
    v_mfma_f32_16x16x32_bf16 v[64:67], v[88:91], v[164:167], v[64:67]
    s_movk_i32 s53, 12288
    buffer_load_dwordx4 v[156:159], v11, s[20:23], s53 offen offset:0 sc1
    buffer_load_dwordx4 v[160:163], v11, s[20:23], s53 offen offset:1024 sc1
    buffer_load_dwordx4 v[164:167], v11, s[20:23], s53 offen offset:2048 sc1
    v_mov_b32 v6, 0
    v_mov_b32 v7, 0
    v_mov_b32 v34, 0x3f803f80
    s_mul_i32 s35, s29, 2304
    s_add_u32 s35, s35, s68
    s_add_u32 s35, s35, 4718592
    v_cvt_pk_bf16_f32 v68, v48, v49
    v_cvt_pk_bf16_f32 v69, v50, v51
    v_dot2c_f32_bf16 v6, v68, v34
    v_dot2c_f32_bf16 v7, v68, v68
    v_dot2c_f32_bf16 v6, v69, v34
    v_dot2c_f32_bf16 v7, v69, v69
    v_cvt_pk_bf16_f32 v70, v52, v53
    v_cvt_pk_bf16_f32 v71, v54, v55
    v_dot2c_f32_bf16 v6, v70, v34
    v_dot2c_f32_bf16 v7, v70, v70
    v_dot2c_f32_bf16 v6, v71, v34
    v_dot2c_f32_bf16 v7, v71, v71
    v_permlane16_swap_b32 v68, v70
    v_permlane16_swap_b32 v69, v71
    buffer_store_dwordx4 v[68:71], v22, s[16:19], s35 offen offset:0 sc1
    v_cvt_pk_bf16_f32 v72, v56, v57
    v_cvt_pk_bf16_f32 v73, v58, v59
    v_dot2c_f32_bf16 v6, v72, v34
    v_dot2c_f32_bf16 v7, v72, v72
    v_dot2c_f32_bf16 v6, v73, v34
    v_dot2c_f32_bf16 v7, v73, v73
    v_cvt_pk_bf16_f32 v74, v60, v61
    v_cvt_pk_bf16_f32 v75, v62, v63
    v_dot2c_f32_bf16 v6, v74, v34
    v_dot2c_f32_bf16 v7, v74, v74
    v_dot2c_f32_bf16 v6, v75, v34
    v_dot2c_f32_bf16 v7, v75, v75
    v_permlane16_swap_b32 v72, v74
    v_permlane16_swap_b32 v73, v75
    buffer_store_dwordx4 v[72:75], v22, s[16:19], s35 offen offset:1024 sc1
    v_cvt_pk_bf16_f32 v76, v64, v65
    v_cvt_pk_bf16_f32 v77, v66, v67
    s_mov_b32 exec_lo, 0xffffffff
    s_mov_b32 exec_hi, 0x0
    v_dot2c_f32_bf16 v6, v76, v34
    v_dot2c_f32_bf16 v7, v76, v76
    v_dot2c_f32_bf16 v6, v77, v34
    v_dot2c_f32_bf16 v7, v77, v77
    s_mov_b64 exec, -1
    v_permlane16_swap_b32 v76, v78
    v_permlane16_swap_b32 v77, v79
    s_mov_b32 exec_lo, 0xffff
    s_mov_b32 exec_hi, 0x0
    buffer_store_dwordx4 v[76:79], v22, s[16:19], s35 offen offset:2048 sc1
    s_mov_b64 exec, -1
    v_mov_b32 v32, v6
    v_mov_b32 v33, v7
    s_nop 0
    v_permlane16_swap_b32 v6, v32
    v_permlane16_swap_b32 v7, v33
    v_add_f32 v6, v6, v32
    v_add_f32 v7, v7, v33
    v_mov_b32 v32, v6
    v_mov_b32 v33, v7
    s_nop 0
    v_permlane32_swap_b32 v6, v32
    v_permlane32_swap_b32 v7, v33
    v_add_f32 v6, v6, v32
    v_add_f32 v7, v7, v33
    v_lshlrev_b32 v32, 4, v2
    s_lshl_b32 s35, s48, 10
    s_lshr_b32 s34, s29, 1
    s_lshl_b32 s34, s34, 8
    s_add_u32 s35, s35, s34
    s_and_b32 s34, s29, 1
    s_lshl_b32 s34, s34, 3
    s_add_u32 s35, s35, s34
    s_add_u32 s35, s35, 7245824
    s_mul_i32 s34, s28, 0
    s_add_u32 s35, s35, s34
    s_mov_b32 exec_lo, 0xffff
    s_mov_b32 exec_hi, 0x0
    buffer_store_dwordx2 v[6:7], v32, s[16:19], s35 offen sc1
    s_mov_b64 exec, -1
    s_lshl_b32 s34, s28, 7
    s_lshl_b32 s35, s29, 3
    s_add_u32 s34, s34, s35
    s_add_u32 s34, s34, 7081984
    s_waitcnt vmcnt(0)
    v_mov_b32 v12, 163352
    v_mov_b32 v13, 1
    s_mov_b32 exec_lo, 0x1
    s_mov_b32 exec_hi, 0x0
    ds_add_rtn_u32 v14, v12, v13
    s_mov_b64 exec, -1
    s_waitcnt lgkmcnt(0)
    v_readfirstlane_b32 s3, v14
    s_nop 0
    s_cmp_lg_u32 s3, 3
    s_cbranch_scc1 mega_arr_h
    v_mov_b32 v12, 0
    v_mov_b32 v14, s66
    v_mov_b32 v15, s67
    s_mov_b32 exec_lo, 0x1
    s_mov_b32 exec_hi, 0x0
    buffer_store_dwordx2 v[14:15], v12, s[16:19], s34 offen sc1
    s_mov_b64 exec, -1
mega_arr_h:
ffn_join:
    s_setprio 0
    v_and_b32 v2, 15, v1
    v_lshrrev_b32 v3, 4, v1
    s_lshl_b32 s34, s47, 2
    s_and_b32 s35, s30, 3
    s_add_u32 s34, s34, s35
    s_mul_i32 s41, s34, 18432
    s_lshr_b32 s35, s30, 2
    s_lshl_b32 s35, s35, 10
    s_add_u32 s41, s41, s35
    s_add_u32 s41, s41, 4718592
    s_mul_i32 s35, s47, 0
    s_add_u32 s41, s41, s35
    s_lshl_b32 s42, s30, 10
    s_lshl_b32 s34, s30, 7
    s_add_u32 s34, s34, 161024
    v_lshlrev_b32 v13, 4, v3
    v_add_u32 v12, s34, v13
    s_lshl_b32 s34, s30, 6
    s_add_u32 s34, s34, 162560
    v_add_u32 v13, s34, v13
    ds_read_b128 v[32:35], v12
    ds_read_b128 v[36:39], v12 offset:64
    ds_read_b128 v[40:43], v13
    v_lshlrev_b32 v9, 2, v2
    v_add_u32 v9, 151808, v9
    s_and_b32 s34, s46, 3
    s_lshl_b32 s34, s34, 6
    v_add_u32 v10, s34, v9
    s_movk_i32 s53, 18432
    s_cmp_lg_u32 s30, 0
    s_cbranch_scc1 ffn_g
    v_and_b32 v12, 7, v1
    v_lshlrev_b32 v12, 3, v12
    s_lshl_b32 s34, s47, 7
    s_add_u32 s34, s34, 7081984
    v_lshlrev_b32 v8, 10, v3
    v_lshl_add_u32 v8, v2, 4, v8
    s_mul_i32 s35, s47, 4096
    s_add_u32 s35, s35, 7245824
    v_mov_b32 v14, 163352
    s_mov_b32 s3, 524288
mega_lw_own:
    ds_read_b32 v15, v14
    s_waitcnt lgkmcnt(0)
    v_readfirstlane_b32 s39, v15
    s_nop 0
    s_cmp_ge_u32 s39, 4
    s_cbranch_scc1 mega_lwd_own
    s_sleep 2
    s_sub_u32 s3, s3, 1
    s_cbranch_scc0 mega_lw_own
mega_lwd_own:
    s_mov_b32 s3, 65536
mega_poll_h:
    s_sleep 3
    buffer_load_dwordx2 v[14:15], v12, s[16:19], s34 offen sc1
    s_waitcnt vmcnt(0)
    v_cmp_eq_u64 vcc, s[66:67], v[14:15]
    s_nop 0
    s_cmp_eq_u64 vcc, -1
    s_cbranch_scc1 mega_polld_h
    s_sub_u32 s3, s3, 1
    s_cbranch_scc0 mega_poll_h
mega_polld_h:
    buffer_load_dwordx4 v[16:19], v8, s[16:19], s35 offen offset:0 sc1
    buffer_load_dwordx4 v[20:23], v8, s[16:19], s35 offen offset:256 sc1
    buffer_load_dwordx4 v[24:27], v8, s[16:19], s35 offen offset:512 sc1
    buffer_load_dwordx4 v[28:31], v8, s[16:19], s35 offen offset:768 sc1
ffn_g:
    s_barrier
    s_add_u32 m0, s42, 0
    s_add_u32 s36, s41, 0
    buffer_load_dwordx4 v11, s[16:19], s36 offen  sc1 lds
    s_add_u32 m0, s42, 12288
    s_add_u32 s36, s41, 3072
    buffer_load_dwordx4 v11, s[16:19], s36 offen  sc1 lds
    s_cmp_lg_u32 s30, 0
    s_cbranch_scc1 ffn_st
    s_waitcnt vmcnt(2)
    v_add_f32 v16, v16, v20
    v_add_f32 v17, v17, v21
    v_add_f32 v18, v18, v22
    v_add_f32 v19, v19, v23
    v_add_f32 v16, v16, v24
    v_add_f32 v17, v17, v25
    v_add_f32 v18, v18, v26
    v_add_f32 v19, v19, v27
    v_add_f32 v16, v16, v28
    v_add_f32 v17, v17, v29
    v_add_f32 v18, v18, v30
    v_add_f32 v19, v19, v31
    v_add_f32 v4, v16, v18
    v_add_f32 v5, v17, v19
    v_mul_f32 v4, 0xbae38e39, v4
    v_mul_f32 v5, 0x3ae38e39, v5
    v_fma_f32 v5, -v4, v4, v5
    v_max_f32 v5, 0, v5
    v_add_f32 v5, 0x3727c5ac, v5
    v_rsq_f32 v5, v5
    v_lshlrev_b32 v6, 2, v1
    v_add_u32 v6, 151808, v6
    ds_write_b32 v6, v4
    ds_write_b32 v6, v5 offset:256
    v_mov_b32 v12, 163448
    v_mov_b32 v13, 1
    s_mov_b32 exec_lo, 0x1
    s_mov_b32 exec_hi, 0x0
    ds_add_u32 v12, v13
    s_mov_b64 exec, -1
ffn_st:
    v_mov_b32 v12, 163448
    s_mov_b32 s3, 524288
mega_lw_mus:
    ds_read_b32 v13, v12
    s_waitcnt lgkmcnt(0)
    v_readfirstlane_b32 s39, v13
    s_nop 0
    s_cmp_ge_u32 s39, 1
    s_cbranch_scc1 mega_lwd_mus
    s_sleep 1
    s_sub_u32 s3, s3, 1
    s_cbranch_scc0 mega_lw_mus
mega_lwd_mus:
    s_add_u32 m0, s42, 24576
    s_add_u32 s36, s41, 6144
    buffer_load_dwordx4 v11, s[16:19], s36 offen  sc1 lds
    s_add_u32 m0, s42, 36864
    s_add_u32 s36, s41, 9216
    buffer_load_dwordx4 v11, s[16:19], s36 offen  sc1 lds
    ds_read_b32 v4, v9 offset:0
    ds_read_b32 v5, v9 offset:64
    ds_read_b32 v6, v9 offset:128
    ds_read_b32 v7, v9 offset:192
    ds_read_b32 v8, v10 offset:256
    s_waitcnt lgkmcnt(0)
    v_mul_f32 v48, v4, v32
    v_mul_f32 v49, v4, v33
    v_mul_f32 v50, v4, v34
    v_mul_f32 v51, v4, v35
    v_mul_f32 v52, v5, v32
    v_mul_f32 v53, v5, v33
    v_mul_f32 v54, v5, v34
    v_mul_f32 v55, v5, v35
    v_mul_f32 v56, v6, v32
    v_mul_f32 v57, v6, v33
    v_mul_f32 v58, v6, v34
    v_mul_f32 v59, v6, v35
    v_mul_f32 v60, v7, v32
    v_mul_f32 v61, v7, v33
    v_mul_f32 v62, v7, v34
    v_mul_f32 v63, v7, v35
    v_mul_f32 v64, v4, v36
    v_mul_f32 v65, v4, v37
    v_mul_f32 v66, v4, v38
    v_mul_f32 v67, v4, v39
    v_mul_f32 v68, v5, v36
    v_mul_f32 v69, v5, v37
    v_mul_f32 v70, v5, v38
    v_mul_f32 v71, v5, v39
    v_mul_f32 v72, v6, v36
    v_mul_f32 v73, v6, v37
    v_mul_f32 v74, v6, v38
    v_mul_f32 v75, v6, v39
    v_mul_f32 v76, v7, v36
    v_mul_f32 v77, v7, v37
    v_mul_f32 v78, v7, v38
    v_mul_f32 v79, v7, v39
    v_mul_f32 v80, v4, v40
    v_mul_f32 v81, v4, v41
    v_mul_f32 v82, v4, v42
    v_mul_f32 v83, v4, v43
    v_mul_f32 v84, v5, v40
    v_mul_f32 v85, v5, v41
    v_mul_f32 v86, v5, v42
    v_mul_f32 v87, v5, v43
    v_mul_f32 v88, v6, v40
    v_mul_f32 v89, v6, v41
    v_mul_f32 v90, v6, v42
    v_mul_f32 v91, v6, v43
    v_mul_f32 v92, v7, v40
    v_mul_f32 v93, v7, v41
    v_mul_f32 v94, v7, v42
    v_mul_f32 v95, v7, v43
    s_add_u32 s41, s41, 12288
    s_add_u32 s42, s42, 49152
    s_waitcnt vmcnt(3)
    s_barrier
    v_mov_b32 v10, v11
    s_mov_b32 s31, 0
    ds_read_b128 v[16:19], v10 offset:0
    ds_read_b128 v[20:23], v10 offset:1024
    ds_read_b128 v[24:27], v10 offset:2048
    ds_read_b128 v[28:31], v10 offset:3072
    s_waitcnt lgkmcnt(0)
    v_mfma_f32_16x16x32_bf16 v[48:51], v[108:111], v[16:19], v[48:51]
    ds_read_b128 v[32:35], v10 offset:4096
    v_mfma_f32_16x16x32_bf16 v[52:55], v[108:111], v[20:23], v[52:55]
    ds_read_b128 v[36:39], v10 offset:5120
    v_mfma_f32_16x16x32_bf16 v[56:59], v[108:111], v[24:27], v[56:59]
    ds_read_b128 v[40:43], v10 offset:6144
    v_mfma_f32_16x16x32_bf16 v[60:63], v[108:111], v[28:31], v[60:63]
    ds_read_b128 v[44:47], v10 offset:7168
    v_mfma_f32_16x16x32_bf16 v[64:67], v[112:115], v[16:19], v[64:67]
    v_mfma_f32_16x16x32_bf16 v[68:71], v[112:115], v[20:23], v[68:71]
    v_mfma_f32_16x16x32_bf16 v[72:75], v[112:115], v[24:27], v[72:75]
    v_mfma_f32_16x16x32_bf16 v[76:79], v[112:115], v[28:31], v[76:79]
    v_mfma_f32_16x16x32_bf16 v[80:83], v[116:119], v[16:19], v[80:83]
    v_mfma_f32_16x16x32_bf16 v[84:87], v[116:119], v[20:23], v[84:87]
    v_mfma_f32_16x16x32_bf16 v[88:91], v[116:119], v[24:27], v[88:91]
    v_mfma_f32_16x16x32_bf16 v[92:95], v[116:119], v[28:31], v[92:95]
    s_branch ffn_u1
ffn_start:
    ds_read_b128 v[16:19], v10 offset:0
    ds_read_b128 v[20:23], v10 offset:1024
    ds_read_b128 v[24:27], v10 offset:2048
    ds_read_b128 v[28:31], v10 offset:3072
    .p2align 6
ffn_loop:
    s_cmp_lg_u32 s31, 1
    s_cbranch_scc1 ffn_nodma
    s_add_u32 m0, s42, 0
    s_add_u32 s36, s41, 0
    buffer_load_dwordx4 v11, s[16:19], s36 offen  sc1 lds
    s_add_u32 m0, s42, 12288
    s_add_u32 s36, s41, 3072
    buffer_load_dwordx4 v11, s[16:19], s36 offen  sc1 lds
    v_min_u32 v0, 13, v1
    v_lshlrev_b32 v0, 7, v0
    s_mul_i32 s36, s47, 1728
    s_and_b32 s36, s36, 0xffffff80
    s_add_u32 s36, s36, 55296
    buffer_load_dword v0, v0, s[20:23], s36 offen sc1
ffn_nodma:
    s_waitcnt vmcnt(12) lgkmcnt(0)
    v_mfma_f32_16x16x32_bf16 v[48:51], v[108:111], v[16:19], v[48:51]
    ds_read_b128 v[32:35], v10 offset:4096
    v_mfma_f32_16x16x32_bf16 v[52:55], v[108:111], v[20:23], v[52:55]
    ds_read_b128 v[36:39], v10 offset:5120
    v_mfma_f32_16x16x32_bf16 v[56:59], v[108:111], v[24:27], v[56:59]
    ds_read_b128 v[40:43], v10 offset:6144
    v_mfma_f32_16x16x32_bf16 v[60:63], v[108:111], v[28:31], v[60:63]
    ds_read_b128 v[44:47], v10 offset:7168
    v_mfma_f32_16x16x32_bf16 v[64:67], v[112:115], v[16:19], v[64:67]
    buffer_load_dwordx4 v[96:99], v11, s[20:23], s53 offen offset:0 sc1
    v_mfma_f32_16x16x32_bf16 v[68:71], v[112:115], v[20:23], v[68:71]
    buffer_load_dwordx4 v[100:103], v11, s[20:23], s53 offen offset:1024 sc1
    v_mfma_f32_16x16x32_bf16 v[72:75], v[112:115], v[24:27], v[72:75]
    buffer_load_dwordx4 v[104:107], v11, s[20:23], s53 offen offset:2048 sc1
    v_mfma_f32_16x16x32_bf16 v[76:79], v[112:115], v[28:31], v[76:79]
    s_add_u32 s53, s53, 3072
    v_mfma_f32_16x16x32_bf16 v[80:83], v[116:119], v[16:19], v[80:83]
    v_mfma_f32_16x16x32_bf16 v[84:87], v[116:119], v[20:23], v[84:87]
    v_mfma_f32_16x16x32_bf16 v[88:91], v[116:119], v[24:27], v[88:91]
    v_mfma_f32_16x16x32_bf16 v[92:95], v[116:119], v[28:31], v[92:95]
ffn_u1:
    s_waitcnt vmcnt(12) lgkmcnt(0)
    v_mfma_f32_16x16x32_bf16 v[48:51], v[120:123], v[32:35], v[48:51]
    ds_read_b128 v[16:19], v10 offset:8192
    v_mfma_f32_16x16x32_bf16 v[52:55], v[120:123], v[36:39], v[52:55]
    ds_read_b128 v[20:23], v10 offset:9216
    v_mfma_f32_16x16x32_bf16 v[56:59], v[120:123], v[40:43], v[56:59]
    ds_read_b128 v[24:27], v10 offset:10240
    v_mfma_f32_16x16x32_bf16 v[60:63], v[120:123], v[44:47], v[60:63]
    ds_read_b128 v[28:31], v10 offset:11264
    v_mfma_f32_16x16x32_bf16 v[64:67], v[124:127], v[32:35], v[64:67]
    buffer_load_dwordx4 v[108:111], v11, s[20:23], s53 offen offset:0 sc1
    v_mfma_f32_16x16x32_bf16 v[68:71], v[124:127], v[36:39], v[68:71]
    buffer_load_dwordx4 v[112:115], v11, s[20:23], s53 offen offset:1024 sc1
    v_mfma_f32_16x16x32_bf16 v[72:75], v[124:127], v[40:43], v[72:75]
    buffer_load_dwordx4 v[116:119], v11, s[20:23], s53 offen offset:2048 sc1
    v_mfma_f32_16x16x32_bf16 v[76:79], v[124:127], v[44:47], v[76:79]
    s_add_u32 s53, s53, 3072
    v_mfma_f32_16x16x32_bf16 v[80:83], v[128:131], v[32:35], v[80:83]
    v_mfma_f32_16x16x32_bf16 v[84:87], v[128:131], v[36:39], v[84:87]
    v_mfma_f32_16x16x32_bf16 v[88:91], v[128:131], v[40:43], v[88:91]
    v_mfma_f32_16x16x32_bf16 v[92:95], v[128:131], v[44:47], v[92:95]
    s_waitcnt vmcnt(12) lgkmcnt(0)
    s_cmp_lg_u32 s31, 0
    s_cbranch_scc1 ffn_nobar2
    s_waitcnt vmcnt(5)
    s_barrier
ffn_nobar2:
    v_mfma_f32_16x16x32_bf16 v[48:51], v[132:135], v[16:19], v[48:51]
    ds_read_b128 v[32:35], v10 offset:12288
    v_mfma_f32_16x16x32_bf16 v[52:55], v[132:135], v[20:23], v[52:55]
    ds_read_b128 v[36:39], v10 offset:13312
    v_mfma_f32_16x16x32_bf16 v[56:59], v[132:135], v[24:27], v[56:59]
    ds_read_b128 v[40:43], v10 offset:14336
    v_mfma_f32_16x16x32_bf16 v[60:63], v[132:135], v[28:31], v[60:63]
    ds_read_b128 v[44:47], v10 offset:15360
    v_mfma_f32_16x16x32_bf16 v[64:67], v[136:139], v[16:19], v[64:67]
    buffer_load_dwordx4 v[120:123], v11, s[20:23], s53 offen offset:0 sc1
    v_mfma_f32_16x16x32_bf16 v[68:71], v[136:139], v[20:23], v[68:71]
    buffer_load_dwordx4 v[124:127], v11, s[20:23], s53 offen offset:1024 sc1
    v_mfma_f32_16x16x32_bf16 v[72:75], v[136:139], v[24:27], v[72:75]
    buffer_load_dwordx4 v[128:131], v11, s[20:23], s53 offen offset:2048 sc1
    v_mfma_f32_16x16x32_bf16 v[76:79], v[136:139], v[28:31], v[76:79]
    s_add_u32 s53, s53, 3072
    v_mfma_f32_16x16x32_bf16 v[80:83], v[140:143], v[16:19], v[80:83]
    v_mfma_f32_16x16x32_bf16 v[84:87], v[140:143], v[20:23], v[84:87]
    v_mfma_f32_16x16x32_bf16 v[88:91], v[140:143], v[24:27], v[88:91]
    v_mfma_f32_16x16x32_bf16 v[92:95], v[140:143], v[28:31], v[92:95]
    s_waitcnt vmcnt(12) lgkmcnt(0)
    v_mfma_f32_16x16x32_bf16 v[48:51], v[144:147], v[32:35], v[48:51]
    ds_read_b128 v[16:19], v10 offset:16384
    v_mfma_f32_16x16x32_bf16 v[52:55], v[144:147], v[36:39], v[52:55]
    ds_read_b128 v[20:23], v10 offset:17408
    v_mfma_f32_16x16x32_bf16 v[56:59], v[144:147], v[40:43], v[56:59]
    ds_read_b128 v[24:27], v10 offset:18432
    v_mfma_f32_16x16x32_bf16 v[60:63], v[144:147], v[44:47], v[60:63]
    ds_read_b128 v[28:31], v10 offset:19456
    v_mfma_f32_16x16x32_bf16 v[64:67], v[148:151], v[32:35], v[64:67]
    buffer_load_dwordx4 v[132:135], v11, s[20:23], s53 offen offset:0 sc1
    v_mfma_f32_16x16x32_bf16 v[68:71], v[148:151], v[36:39], v[68:71]
    buffer_load_dwordx4 v[136:139], v11, s[20:23], s53 offen offset:1024 sc1
    v_mfma_f32_16x16x32_bf16 v[72:75], v[148:151], v[40:43], v[72:75]
    buffer_load_dwordx4 v[140:143], v11, s[20:23], s53 offen offset:2048 sc1
    v_mfma_f32_16x16x32_bf16 v[76:79], v[148:151], v[44:47], v[76:79]
    s_add_u32 s53, s53, 3072
    v_mfma_f32_16x16x32_bf16 v[80:83], v[152:155], v[32:35], v[80:83]
    v_mfma_f32_16x16x32_bf16 v[84:87], v[152:155], v[36:39], v[84:87]
    v_mfma_f32_16x16x32_bf16 v[88:91], v[152:155], v[40:43], v[88:91]
    v_mfma_f32_16x16x32_bf16 v[92:95], v[152:155], v[44:47], v[92:95]
    s_waitcnt vmcnt(12) lgkmcnt(0)
    v_mfma_f32_16x16x32_bf16 v[48:51], v[156:159], v[16:19], v[48:51]
    ds_read_b128 v[32:35], v10 offset:20480
    v_mfma_f32_16x16x32_bf16 v[52:55], v[156:159], v[20:23], v[52:55]
    ds_read_b128 v[36:39], v10 offset:21504
    v_mfma_f32_16x16x32_bf16 v[56:59], v[156:159], v[24:27], v[56:59]
    ds_read_b128 v[40:43], v10 offset:22528
    v_mfma_f32_16x16x32_bf16 v[60:63], v[156:159], v[28:31], v[60:63]
    ds_read_b128 v[44:47], v10 offset:23552
    v_mfma_f32_16x16x32_bf16 v[64:67], v[160:163], v[16:19], v[64:67]
    buffer_load_dwordx4 v[144:147], v11, s[20:23], s53 offen offset:0 sc1
    v_mfma_f32_16x16x32_bf16 v[68:71], v[160:163], v[20:23], v[68:71]
    buffer_load_dwordx4 v[148:151], v11, s[20:23], s53 offen offset:1024 sc1
    v_mfma_f32_16x16x32_bf16 v[72:75], v[160:163], v[24:27], v[72:75]
    buffer_load_dwordx4 v[152:155], v11, s[20:23], s53 offen offset:2048 sc1
    v_mfma_f32_16x16x32_bf16 v[76:79], v[160:163], v[28:31], v[76:79]
    s_add_u32 s53, s53, 3072
    v_mfma_f32_16x16x32_bf16 v[80:83], v[164:167], v[16:19], v[80:83]
    v_mfma_f32_16x16x32_bf16 v[84:87], v[164:167], v[20:23], v[84:87]
    v_mfma_f32_16x16x32_bf16 v[88:91], v[164:167], v[24:27], v[88:91]
    v_mfma_f32_16x16x32_bf16 v[92:95], v[164:167], v[28:31], v[92:95]
    s_waitcnt vmcnt(12) lgkmcnt(0)
    s_cmp_ge_u32 s31, 2
    s_cbranch_scc1 ffn_hwait
    s_barrier
ffn_nobar:
    v_mfma_f32_16x16x32_bf16 v[48:51], v[96:99], v[32:35], v[48:51]
    ds_read_b128 v[16:19], v10 offset:24576
    v_mfma_f32_16x16x32_bf16 v[52:55], v[96:99], v[36:39], v[52:55]
    ds_read_b128 v[20:23], v10 offset:25600
    v_mfma_f32_16x16x32_bf16 v[56:59], v[96:99], v[40:43], v[56:59]
    ds_read_b128 v[24:27], v10 offset:26624
    v_mfma_f32_16x16x32_bf16 v[60:63], v[96:99], v[44:47], v[60:63]
    ds_read_b128 v[28:31], v10 offset:27648
    v_mfma_f32_16x16x32_bf16 v[64:67], v[100:103], v[32:35], v[64:67]
    buffer_load_dwordx4 v[156:159], v11, s[20:23], s53 offen offset:0 sc1
    v_mfma_f32_16x16x32_bf16 v[68:71], v[100:103], v[36:39], v[68:71]
    buffer_load_dwordx4 v[160:163], v11, s[20:23], s53 offen offset:1024 sc1
    v_mfma_f32_16x16x32_bf16 v[72:75], v[100:103], v[40:43], v[72:75]
    buffer_load_dwordx4 v[164:167], v11, s[20:23], s53 offen offset:2048 sc1
    v_mfma_f32_16x16x32_bf16 v[76:79], v[100:103], v[44:47], v[76:79]
    s_add_u32 s53, s53, 3072
    v_mfma_f32_16x16x32_bf16 v[80:83], v[104:107], v[32:35], v[80:83]
    v_mfma_f32_16x16x32_bf16 v[84:87], v[104:107], v[36:39], v[84:87]
    v_mfma_f32_16x16x32_bf16 v[88:91], v[104:107], v[40:43], v[88:91]
    v_mfma_f32_16x16x32_bf16 v[92:95], v[104:107], v[44:47], v[92:95]
    v_add_u32 v10, 24576, v10
    s_add_u32 s31, s31, 1
    s_cmp_eq_u32 s31, 3
    s_cbranch_scc1 ffn_ep1
    s_cmp_lt_u32 s31, 5
    s_cbranch_scc1 ffn_loop
    s_waitcnt vmcnt(12) lgkmcnt(0)
    v_mfma_f32_16x16x32_bf16 v[48:51], v[108:111], v[16:19], v[48:51]
    ds_read_b128 v[32:35], v10 offset:4096
    v_mfma_f32_16x16x32_bf16 v[52:55], v[108:111], v[20:23], v[52:55]
    ds_read_b128 v[36:39], v10 offset:5120
    v_mfma_f32_16x16x32_bf16 v[56:59], v[108:111], v[24:27], v[56:59]
    ds_read_b128 v[40:43], v10 offset:6144
    v_mfma_f32_16x16x32_bf16 v[60:63], v[108:111], v[28:31], v[60:63]
    ds_read_b128 v[44:47], v10 offset:7168
    v_mfma_f32_16x16x32_bf16 v[64:67], v[112:115], v[16:19], v[64:67]
    buffer_load_dwordx4 v[96:99], v11, s[20:23], s53 offen offset:0 sc1
    v_mfma_f32_16x16x32_bf16 v[68:71], v[112:115], v[20:23], v[68:71]
    buffer_load_dwordx4 v[100:103], v11, s[20:23], s53 offen offset:1024 sc1
    v_mfma_f32_16x16x32_bf16 v[72:75], v[112:115], v[24:27], v[72:75]
    buffer_load_dwordx4 v[104:107], v11, s[20:23], s53 offen offset:2048 sc1
    v_mfma_f32_16x16x32_bf16 v[76:79], v[112:115], v[28:31], v[76:79]
    s_add_u32 s53, s53, 3072
    v_mfma_f32_16x16x32_bf16 v[80:83], v[116:119], v[16:19], v[80:83]
    v_mfma_f32_16x16x32_bf16 v[84:87], v[116:119], v[20:23], v[84:87]
    v_mfma_f32_16x16x32_bf16 v[88:91], v[116:119], v[24:27], v[88:91]
    v_mfma_f32_16x16x32_bf16 v[92:95], v[116:119], v[28:31], v[92:95]
    s_waitcnt vmcnt(12) lgkmcnt(0)
    v_mfma_f32_16x16x32_bf16 v[48:51], v[120:123], v[32:35], v[48:51]
    ds_read_b128 v[16:19], v10 offset:8192
    v_mfma_f32_16x16x32_bf16 v[52:55], v[120:123], v[36:39], v[52:55]
    ds_read_b128 v[20:23], v10 offset:9216
    v_mfma_f32_16x16x32_bf16 v[56:59], v[120:123], v[40:43], v[56:59]
    ds_read_b128 v[24:27], v10 offset:10240
    v_mfma_f32_16x16x32_bf16 v[60:63], v[120:123], v[44:47], v[60:63]
    ds_read_b128 v[28:31], v10 offset:11264
    v_mfma_f32_16x16x32_bf16 v[64:67], v[124:127], v[32:35], v[64:67]
    v_mfma_f32_16x16x32_bf16 v[68:71], v[124:127], v[36:39], v[68:71]
    v_mfma_f32_16x16x32_bf16 v[72:75], v[124:127], v[40:43], v[72:75]
    v_mfma_f32_16x16x32_bf16 v[76:79], v[124:127], v[44:47], v[76:79]
    v_mfma_f32_16x16x32_bf16 v[80:83], v[128:131], v[32:35], v[80:83]
    v_mfma_f32_16x16x32_bf16 v[84:87], v[128:131], v[36:39], v[84:87]
    v_mfma_f32_16x16x32_bf16 v[88:91], v[128:131], v[40:43], v[88:91]
    v_mfma_f32_16x16x32_bf16 v[92:95], v[128:131], v[44:47], v[92:95]
    s_waitcnt vmcnt(9) lgkmcnt(0)
    v_mfma_f32_16x16x32_bf16 v[48:51], v[132:135], v[16:19], v[48:51]
    ds_read_b128 v[32:35], v10 offset:12288
    v_mfma_f32_16x16x32_bf16 v[52:55], v[132:135], v[20:23], v[52:55]
    ds_read_b128 v[36:39], v10 offset:13312
    v_mfma_f32_16x16x32_bf16 v[56:59], v[132:135], v[24:27], v[56:59]
    ds_read_b128 v[40:43], v10 offset:14336
    v_mfma_f32_16x16x32_bf16 v[60:63], v[132:135], v[28:31], v[60:63]
    ds_read_b128 v[44:47], v10 offset:15360
    v_mfma_f32_16x16x32_bf16 v[64:67], v[136:139], v[16:19], v[64:67]
    v_mfma_f32_16x16x32_bf16 v[68:71], v[136:139], v[20:23], v[68:71]
    v_mfma_f32_16x16x32_bf16 v[72:75], v[136:139], v[24:27], v[72:75]
    v_mfma_f32_16x16x32_bf16 v[76:79], v[136:139], v[28:31], v[76:79]
    v_mfma_f32_16x16x32_bf16 v[80:83], v[140:143], v[16:19], v[80:83]
    v_mfma_f32_16x16x32_bf16 v[84:87], v[140:143], v[20:23], v[84:87]
    v_mfma_f32_16x16x32_bf16 v[88:91], v[140:143], v[24:27], v[88:91]
    v_mfma_f32_16x16x32_bf16 v[92:95], v[140:143], v[28:31], v[92:95]
    s_waitcnt vmcnt(6) lgkmcnt(0)
    v_mfma_f32_16x16x32_bf16 v[48:51], v[144:147], v[32:35], v[48:51]
    ds_read_b128 v[16:19], v10 offset:16384
    v_mfma_f32_16x16x32_bf16 v[52:55], v[144:147], v[36:39], v[52:55]
    ds_read_b128 v[20:23], v10 offset:17408
    v_mfma_f32_16x16x32_bf16 v[56:59], v[144:147], v[40:43], v[56:59]
    ds_read_b128 v[24:27], v10 offset:18432
    v_mfma_f32_16x16x32_bf16 v[60:63], v[144:147], v[44:47], v[60:63]
    ds_read_b128 v[28:31], v10 offset:19456
    v_mfma_f32_16x16x32_bf16 v[64:67], v[148:151], v[32:35], v[64:67]
    v_mfma_f32_16x16x32_bf16 v[68:71], v[148:151], v[36:39], v[68:71]
    v_mfma_f32_16x16x32_bf16 v[72:75], v[148:151], v[40:43], v[72:75]
    v_mfma_f32_16x16x32_bf16 v[76:79], v[148:151], v[44:47], v[76:79]
    v_mfma_f32_16x16x32_bf16 v[80:83], v[152:155], v[32:35], v[80:83]
    v_mfma_f32_16x16x32_bf16 v[84:87], v[152:155], v[36:39], v[84:87]
    v_mfma_f32_16x16x32_bf16 v[88:91], v[152:155], v[40:43], v[88:91]
    v_mfma_f32_16x16x32_bf16 v[92:95], v[152:155], v[44:47], v[92:95]
    s_waitcnt vmcnt(3) lgkmcnt(0)
    v_mfma_f32_16x16x32_bf16 v[48:51], v[156:159], v[16:19], v[48:51]
    ds_read_b128 v[32:35], v10 offset:20480
    v_mfma_f32_16x16x32_bf16 v[52:55], v[156:159], v[20:23], v[52:55]
    ds_read_b128 v[36:39], v10 offset:21504
    v_mfma_f32_16x16x32_bf16 v[56:59], v[156:159], v[24:27], v[56:59]
    ds_read_b128 v[40:43], v10 offset:22528
    v_mfma_f32_16x16x32_bf16 v[60:63], v[156:159], v[28:31], v[60:63]
    ds_read_b128 v[44:47], v10 offset:23552
    v_mfma_f32_16x16x32_bf16 v[64:67], v[160:163], v[16:19], v[64:67]
    v_mfma_f32_16x16x32_bf16 v[68:71], v[160:163], v[20:23], v[68:71]
    v_mfma_f32_16x16x32_bf16 v[72:75], v[160:163], v[24:27], v[72:75]
    v_mfma_f32_16x16x32_bf16 v[76:79], v[160:163], v[28:31], v[76:79]
    v_mfma_f32_16x16x32_bf16 v[80:83], v[164:167], v[16:19], v[80:83]
    v_mfma_f32_16x16x32_bf16 v[84:87], v[164:167], v[20:23], v[84:87]
    v_mfma_f32_16x16x32_bf16 v[88:91], v[164:167], v[24:27], v[88:91]
    v_mfma_f32_16x16x32_bf16 v[92:95], v[164:167], v[28:31], v[92:95]
    s_waitcnt vmcnt(0) lgkmcnt(0)
    v_mfma_f32_16x16x32_bf16 v[48:51], v[96:99], v[32:35], v[48:51]
    v_mfma_f32_16x16x32_bf16 v[52:55], v[96:99], v[36:39], v[52:55]
    v_mfma_f32_16x16x32_bf16 v[56:59], v[96:99], v[40:43], v[56:59]
    v_mfma_f32_16x16x32_bf16 v[60:63], v[96:99], v[44:47], v[60:63]
    v_mfma_f32_16x16x32_bf16 v[64:67], v[100:103], v[32:35], v[64:67]
    v_mfma_f32_16x16x32_bf16 v[68:71], v[100:103], v[36:39], v[68:71]
    v_mfma_f32_16x16x32_bf16 v[72:75], v[100:103], v[40:43], v[72:75]
    v_mfma_f32_16x16x32_bf16 v[76:79], v[100:103], v[44:47], v[76:79]
    v_mfma_f32_16x16x32_bf16 v[80:83], v[104:107], v[32:35], v[80:83]
    v_mfma_f32_16x16x32_bf16 v[84:87], v[104:107], v[36:39], v[84:87]
    v_mfma_f32_16x16x32_bf16 v[88:91], v[104:107], v[40:43], v[88:91]
    v_mfma_f32_16x16x32_bf16 v[92:95], v[104:107], v[44:47], v[92:95]
    s_waitcnt lgkmcnt(0)
    s_mul_i32 s34, s46, 73728
    s_mul_i32 s33, s47, 589824
    s_add_u32 s33, s33, 18219008
    s_add_u32 s34, s34, s33
    s_lshl_b32 s35, s30, 10
    s_add_u32 s36, s34, s35
    s_cmp_ge_u32 s30, 6
    s_movk_i32 s37, 12288
    s_cselect_b32 s37, 24576, s37
    s_add_u32 s37, s37, s36
    v_cvt_pk_bf16_f32 v16, v48, v64
    v_cvt_pk_bf16_f32 v17, v49, v65
    v_cvt_pk_bf16_f32 v18, v50, v66
    v_cvt_pk_bf16_f32 v19, v51, v67
    buffer_store_dwordx4 v[16:19], v11, s[16:19], s36 offen sc1
    s_add_u32 s36, s36, 18432
    v_cvt_pk_bf16_f32 v20, v52, v68
    v_cvt_pk_bf16_f32 v21, v53, v69
    v_cvt_pk_bf16_f32 v22, v54, v70
    v_cvt_pk_bf16_f32 v23, v55, v71
    buffer_store_dwordx4 v[20:23], v11, s[16:19], s36 offen sc1
    s_add_u32 s36, s36, 18432
    v_cvt_pk_bf16_f32 v24, v56, v72
    v_cvt_pk_bf16_f32 v25, v57, v73
    v_cvt_pk_bf16_f32 v26, v58, v74
    v_cvt_pk_bf16_f32 v27, v59, v75
    buffer_store_dwordx4 v[24:27], v11, s[16:19], s36 offen sc1
    s_add_u32 s36, s36, 18432
    v_cvt_pk_bf16_f32 v28, v60, v76
    v_cvt_pk_bf16_f32 v29, v61, v77
    v_cvt_pk_bf16_f32 v30, v62, v78
    v_cvt_pk_bf16_f32 v31, v63, v79
    buffer_store_dwordx4 v[28:31], v11, s[16:19], s36 offen sc1
    s_add_u32 s36, s36, 18432
    v_cvt_pk_bf16_f32 v32, v80, v81
    v_cvt_pk_bf16_f32 v33, v82, v83
    v_cvt_pk_bf16_f32 v34, v84, v85
    v_cvt_pk_bf16_f32 v35, v86, v87
    buffer_store_dwordx4 v[32:35], v11, s[16:19], s37 offen sc1
    s_add_u32 s37, s37, 36864
    v_cvt_pk_bf16_f32 v36, v88, v89
    v_cvt_pk_bf16_f32 v37, v90, v91
    v_cvt_pk_bf16_f32 v38, v92, v93
    v_cvt_pk_bf16_f32 v39, v94, v95
    buffer_store_dwordx4 v[36:39], v11, s[16:19], s37 offen sc1
    s_add_u32 s37, s37, 36864
    s_lshl_b32 s38, s47, 9
    s_add_u32 s38, s38, 7090176
    s_lshr_b32 s36, s30, 2
    s_lshl_b32 s35, s36, 7
    s_add_u32 s38, s38, s35
    s_lshl_b32 s35, s46, 3
    s_add_u32 s34, s38, s35
    s_lshl_b32 s44, s36, 2
    s_add_u32 s44, s44, 163356
    s_waitcnt vmcnt(0)
    v_mov_b32 v12, s44
    v_mov_b32 v13, 1
    s_mov_b32 exec_lo, 0x1
    s_mov_b32 exec_hi, 0x0
    ds_add_rtn_u32 v14, v12, v13
    s_mov_b64 exec, -1
    s_waitcnt lgkmcnt(0)
    v_readfirstlane_b32 s3, v14
    s_nop 0
    s_cmp_lg_u32 s3, 3
    s_cbranch_scc1 mega_arr_r
    v_mov_b32 v12, 0
    v_mov_b32 v14, s66
    v_mov_b32 v15, s67
    s_mov_b32 exec_lo, 0x1
    s_mov_b32 exec_hi, 0x0
    buffer_store_dwordx2 v[14:15], v12, s[16:19], s34 offen sc1
    s_mov_b64 exec, -1
mega_arr_r:
    s_add_u32 s44, s44, 12
    v_mov_b32 v10, s44
    s_and_b32 s35, s30, 3
    s_cmp_lg_u32 s35, 3
    s_cbranch_scc1 mega_red
    s_cmp_eq_u32 s30, 3
    s_mov_b32 s35, 163364
    s_cselect_b32 s35, 163360, s35
    v_mov_b32 v12, s35
    s_mov_b32 s3, 524288
mega_lw_t2:
    ds_read_b32 v13, v12
    s_waitcnt lgkmcnt(0)
    v_readfirstlane_b32 s39, v13
    s_nop 0
    s_cmp_ge_u32 s39, 4
    s_cbranch_scc1 mega_lwd_t2
    s_sleep 4
    s_sub_u32 s3, s3, 1
    s_cbranch_scc0 mega_lw_t2
mega_lwd_t2:
    v_and_b32 v12, 7, v1
    v_lshlrev_b32 v12, 3, v12
    s_mov_b32 s3, 65536
mega_poll_r:
    s_sleep 3
    buffer_load_dwordx2 v[14:15], v12, s[16:19], s38 offen sc1
    s_waitcnt vmcnt(0)
    v_cmp_eq_u64 vcc, s[66:67], v[14:15]
    s_nop 0
    s_cmp_eq_u64 vcc, -1
    s_cbranch_scc1 mega_polld_r
    s_sub_u32 s3, s3, 1
    s_cbranch_scc0 mega_poll_r
mega_polld_r:
    v_mov_b32 v13, 1
    ds_write_b32 v10, v13
    s_waitcnt lgkmcnt(0)
    s_branch mega_fin
mega_red:
    s_lshl_b32 s37, s36, 2
    s_lshl_b32 s39, s35, 1
    s_add_u32 s37, s37, s39
    s_lshl_b32 s39, s36, 1
    s_add_u32 s39, s39, 12
    s_cmp_eq_u32 s35, 2
    s_cselect_b32 s37, s39, s37
    s_lshr_b32 s39, s46, 2
    s_add_u32 s37, s37, s39
    s_and_b32 s39, s46, 3
    s_mul_i32 s34, s39, 18432
    s_lshl_b32 s41, s37, 10
    s_add_u32 s34, s34, s41
    s_sub_u32 s41, s37, 12
    s_lshl_b32 s41, s41, 11
    s_cmp_ge_u32 s37, 15
    s_movk_i32 s42, 12288
    s_cselect_b32 s42, 24576, s42
    s_add_u32 s41, s41, s42
    s_lshr_b32 s42, s39, 1
    s_mul_i32 s42, s42, 36864
    s_add_u32 s41, s41, s42
    s_and_b32 s42, s39, 1
    s_lshl_b32 s42, s42, 3
    s_add_u32 s41, s41, s42
    s_mov_b32 s43, s35
    s_cmp_eq_u32 s35, 2
    s_cselect_b32 s34, s41, s34
    s_cselect_b32 s42, 1024, 8
    s_add_u32 s33, s33, s34
    s_add_u32 s42, s42, s33
    s_lshl_b32 s35, s37, 2
    s_add_u32 s35, s35, s39
    s_lshl_b32 s35, s35, 10
    v_add_u32 v13, s35, v11
    ds_read_b128 v[128:131], v13
    s_mov_b32 s20, s14
    s_mov_b32 s21, s15
    s_mov_b32 s22, 0x240000
    s_mov_b32 s23, 0x00020000
    s_lshl_b32 s35, s47, 2
    s_add_u32 s35, s35, s39
    s_mul_i32 s35, s35, 18432
    s_lshl_b32 s37, s37, 6
    s_add_u32 s37, s37, s35
    s_movk_i32 s35, 1152
    v_mul_u32_u24 v9, s35, v2
    v_lshl_add_u32 v9, v3, 4, v9
    v_mov_b32 v5, 0x00003f80
    v_mov_b32 v6, 0x3f800000
    v_mov_b32 v48, 0
    v_mov_b32 v49, 0
    v_mov_b32 v50, 0
    v_mov_b32 v51, 0
    v_mov_b32 v52, 0
    v_mov_b32 v53, 0
    v_mov_b32 v54, 0
    v_mov_b32 v55, 0
    s_mov_b32 s3, 524288
mega_lspin:
    ds_read_b32 v14, v10
    s_waitcnt lgkmcnt(0)
    v_readfirstlane_b32 s38, v14
    s_nop 0
    s_cmp_lg_u32 s38, 0
    s_cbranch_scc1 mega_lspind
    s_sleep 2
    s_sub_u32 s3, s3, 1
    s_cbranch_scc0 mega_lspin
mega_lspind:
    s_cmp_eq_u32 s43, 2
    s_cbranch_scc1 mega_ld_s
    buffer_load_dwordx4 v[96:99], v11, s[16:19], s33 offen sc1
    s_add_u32 s33, s33, 73728
    buffer_load_dwordx4 v[100:103], v11, s[16:19], s33 offen sc1
    s_add_u32 s33, s33, 73728
    buffer_load_dwordx4 v[104:107], v11, s[16:19], s33 offen sc1
    s_add_u32 s33, s33, 73728
    buffer_load_dwordx4 v[108:111], v11, s[16:19], s33 offen sc1
    s_add_u32 s33, s33, 73728
    buffer_load_dwordx4 v[112:115], v11, s[16:19], s33 offen sc1
    s_add_u32 s33, s33, 73728
    buffer_load_dwordx4 v[116:119], v11, s[16:19], s33 offen sc1
    s_add_u32 s33, s33, 73728
    buffer_load_dwordx4 v[120:123], v11, s[16:19], s33 offen sc1
    s_add_u32 s33, s33, 73728
    buffer_load_dwordx4 v[124:127], v11, s[16:19], s33 offen sc1
    s_add_u32 s33, s33, 73728
    s_branch mega_ld_o
mega_ld_s:
    buffer_load_dwordx2 v[96:97], v11, s[16:19], s33 offen sc1
    s_add_u32 s33, s33, 73728
    buffer_load_dwordx2 v[100:101], v11, s[16:19], s33 offen sc1
    s_add_u32 s33, s33, 73728
    buffer_load_dwordx2 v[104:105], v11, s[16:19], s33 offen sc1
    s_add_u32 s33, s33, 73728
    buffer_load_dwordx2 v[108:109], v11, s[16:19], s33 offen sc1
    s_add_u32 s33, s33, 73728
    buffer_load_dwordx2 v[112:113], v11, s[16:19], s33 offen sc1
    s_add_u32 s33, s33, 73728
    buffer_load_dwordx2 v[116:117], v11, s[16:19], s33 offen sc1
    s_add_u32 s33, s33, 73728
    buffer_load_dwordx2 v[120:121], v11, s[16:19], s33 offen sc1
    s_add_u32 s33, s33, 73728
    buffer_load_dwordx2 v[124:125], v11, s[16:19], s33 offen sc1
    s_add_u32 s33, s33, 73728
    buffer_load_dwordx2 v[98:99], v11, s[16:19], s42 offen sc1
    s_add_u32 s42, s42, 73728
    buffer_load_dwordx2 v[102:103], v11, s[16:19], s42 offen sc1
    s_add_u32 s42, s42, 73728
    buffer_load_dwordx2 v[106:107], v11, s[16:19], s42 offen sc1
    s_add_u32 s42, s42, 73728
    buffer_load_dwordx2 v[110:111], v11, s[16:19], s42 offen sc1
    s_add_u32 s42, s42, 73728
    buffer_load_dwordx2 v[114:115], v11, s[16:19], s42 offen sc1
    s_add_u32 s42, s42, 73728
    buffer_load_dwordx2 v[118:119], v11, s[16:19], s42 offen sc1
    s_add_u32 s42, s42, 73728
    buffer_load_dwordx2 v[122:123], v11, s[16:19], s42 offen sc1
    s_add_u32 s42, s42, 73728
    buffer_load_dwordx2 v[126:127], v11, s[16:19], s42 offen sc1
    s_add_u32 s42, s42, 73728
mega_ld_o:
    s_waitcnt lgkmcnt(0)
    v_lshlrev_b32 v56, 16, v128
    v_and_b32 v57, 0xffff0000, v128
    v_lshlrev_b32 v58, 16, v129
    v_and_b32 v59, 0xffff0000, v129
    v_lshlrev_b32 v60, 16, v130
    v_and_b32 v61, 0xffff0000, v130
    v_lshlrev_b32 v62, 16, v131
    v_and_b32 v63, 0xffff0000, v131
    s_waitcnt vmcnt(7)
    v_dot2c_f32_bf16 v48, v96, v5
    v_dot2c_f32_bf16 v49, v96, v6
    v_dot2c_f32_bf16 v50, v97, v5
    v_dot2c_f32_bf16 v51, v97, v6
    v_dot2c_f32_bf16 v52, v98, v5
    v_dot2c_f32_bf16 v53, v98, v6
    v_dot2c_f32_bf16 v54, v99, v5
    v_dot2c_f32_bf16 v55, v99, v6
    s_waitcnt vmcnt(6)
    v_dot2c_f32_bf16 v48, v100, v5
    v_dot2c_f32_bf16 v49, v100, v6
    v_dot2c_f32_bf16 v50, v101, v5
    v_dot2c_f32_bf16 v51, v101, v6
    v_dot2c_f32_bf16 v52, v102, v5
    v_dot2c_f32_bf16 v53, v102, v6
    v_dot2c_f32_bf16 v54, v103, v5
    v_dot2c_f32_bf16 v55, v103, v6
    s_waitcnt vmcnt(5)
    v_dot2c_f32_bf16 v48, v104, v5
    v_dot2c_f32_bf16 v49, v104, v6
    v_dot2c_f32_bf16 v50, v105, v5
    v_dot2c_f32_bf16 v51, v105, v6
    v_dot2c_f32_bf16 v52, v106, v5
    v_dot2c_f32_bf16 v53, v106, v6
    v_dot2c_f32_bf16 v54, v107, v5
    v_dot2c_f32_bf16 v55, v107, v6
    s_waitcnt vmcnt(4)
    v_dot2c_f32_bf16 v48, v108, v5
    v_dot2c_f32_bf16 v49, v108, v6
    v_dot2c_f32_bf16 v50, v109, v5
    v_dot2c_f32_bf16 v51, v109, v6
    v_dot2c_f32_bf16 v52, v110, v5
    v_dot2c_f32_bf16 v53, v110, v6
    v_dot2c_f32_bf16 v54, v111, v5
    v_dot2c_f32_bf16 v55, v111, v6
    s_waitcnt vmcnt(3)
    v_dot2c_f32_bf16 v48, v112, v5
    v_dot2c_f32_bf16 v49, v112, v6
    v_dot2c_f32_bf16 v50, v113, v5
    v_dot2c_f32_bf16 v51, v113, v6
    v_dot2c_f32_bf16 v52, v114, v5
    v_dot2c_f32_bf16 v53, v114, v6
    v_dot2c_f32_bf16 v54, v115, v5
    v_dot2c_f32_bf16 v55, v115, v6
    s_waitcnt vmcnt(2)
    v_dot2c_f32_bf16 v48, v116, v5
    v_dot2c_f32_bf16 v49, v116, v6
    v_dot2c_f32_bf16 v50, v117, v5
    v_dot2c_f32_bf16 v51, v117, v6
    v_dot2c_f32_bf16 v52, v118, v5
    v_dot2c_f32_bf16 v53, v118, v6
    v_dot2c_f32_bf16 v54, v119, v5
    v_dot2c_f32_bf16 v55, v119, v6
    s_waitcnt vmcnt(1)
    v_dot2c_f32_bf16 v48, v120, v5
    v_dot2c_f32_bf16 v49, v120, v6
    v_dot2c_f32_bf16 v50, v121, v5
    v_dot2c_f32_bf16 v51, v121, v6
    v_dot2c_f32_bf16 v52, v122, v5
    v_dot2c_f32_bf16 v53, v122, v6
    v_dot2c_f32_bf16 v54, v123, v5
    v_dot2c_f32_bf16 v55, v123, v6
    s_waitcnt vmcnt(0)
    v_dot2c_f32_bf16 v48, v124, v5
    v_dot2c_f32_bf16 v49, v124, v6
    v_dot2c_f32_bf16 v50, v125, v5
    v_dot2c_f32_bf16 v51, v125, v6
    v_dot2c_f32_bf16 v52, v126, v5
    v_dot2c_f32_bf16 v53, v126, v6
    v_dot2c_f32_bf16 v54, v127, v5
    v_dot2c_f32_bf16 v55, v127, v6
    s_cmp_eq_u32 s43, 2
    s_cbranch_scc1 mega_red_s
    v_fma_f32 v56, v48, v8, v56
    v_fma_f32 v57, v49, v8, v57
    v_fma_f32 v58, v50, v8, v58
    v_fma_f32 v59, v51, v8, v59
    v_fma_f32 v60, v52, v8, v60
    v_fma_f32 v61, v53, v8, v61
    v_fma_f32 v62, v54, v8, v62
    v_fma_f32 v63, v55, v8, v63
    s_branch mega_red_o
mega_red_s:
    v_fma_f32 v56, v48, v8, v56
    v_fma_f32 v57, v52, v8, v57
    v_fma_f32 v58, v49, v8, v58
    v_fma_f32 v59, v53, v8, v59
    v_fma_f32 v60, v50, v8, v60
    v_fma_f32 v61, v54, v8, v61
    v_fma_f32 v62, v51, v8, v62
    v_fma_f32 v63, v55, v8, v63
mega_red_o:
    v_cvt_pk_bf16_f32 v16, v56, v57
    v_cvt_pk_bf16_f32 v17, v58, v59
    v_cvt_pk_bf16_f32 v18, v60, v61
    v_cvt_pk_bf16_f32 v19, v62, v63
    buffer_store_dwordx4 v[16:19], v9, s[20:23], s37 offen
mega_fin:
    s_endpgm
ffn_ep1:
    s_waitcnt lgkmcnt(0)
    s_lshr_b32 s36, s30, 2
    s_mul_i32 s37, s36, 24576
    s_add_u32 s37, s37, 73728
    s_and_b32 s34, s30, 3
    s_lshl_b32 s34, s34, 12
    s_add_u32 s34, s34, s37
    v_add_u32 v14, s34, v11
    s_bfe_u32 s34, s30, 0x10001
    s_lshl_b32 s34, s34, 12
    s_and_b32 s35, s30, 1
    s_lshl_b32 s35, s35, 3
    s_add_u32 s34, s34, s35
    s_add_u32 s34, s34, s37
    s_add_u32 s34, s34, 16384
    v_add_u32 v15, s34, v11
    s_lshl_b32 s36, s36, 2
    s_add_u32 s36, s36, 163472
    v_cvt_pk_bf16_f32 v16, v48, v64
    v_cvt_pk_bf16_f32 v17, v49, v65
    v_cvt_pk_bf16_f32 v18, v50, v66
    v_cvt_pk_bf16_f32 v19, v51, v67
    v_pk_max_i16 v16, v16, 0
    v_pk_max_i16 v17, v17, 0
    v_pk_max_i16 v18, v18, 0
    v_pk_max_i16 v19, v19, 0
    ds_write_b128 v14, v[16:19] offset:0
    v_cvt_pk_bf16_f32 v20, v52, v68
    v_cvt_pk_bf16_f32 v21, v53, v69
    v_cvt_pk_bf16_f32 v22, v54, v70
    v_cvt_pk_bf16_f32 v23, v55, v71
    v_pk_max_i16 v20, v20, 0
    v_pk_max_i16 v21, v21, 0
    v_pk_max_i16 v22, v22, 0
    v_pk_max_i16 v23, v23, 0
    ds_write_b128 v14, v[20:23] offset:1024
    v_cvt_pk_bf16_f32 v24, v56, v72
    v_cvt_pk_bf16_f32 v25, v57, v73
    v_cvt_pk_bf16_f32 v26, v58, v74
    v_cvt_pk_bf16_f32 v27, v59, v75
    v_pk_max_i16 v24, v24, 0
    v_pk_max_i16 v25, v25, 0
    v_pk_max_i16 v26, v26, 0
    v_pk_max_i16 v27, v27, 0
    ds_write_b128 v14, v[24:27] offset:2048
    v_cvt_pk_bf16_f32 v28, v60, v76
    v_cvt_pk_bf16_f32 v29, v61, v77
    v_cvt_pk_bf16_f32 v30, v62, v78
    v_cvt_pk_bf16_f32 v31, v63, v79
    v_pk_max_i16 v28, v28, 0
    v_pk_max_i16 v29, v29, 0
    v_pk_max_i16 v30, v30, 0
    v_pk_max_i16 v31, v31, 0
    ds_write_b128 v14, v[28:31] offset:3072
    v_cvt_pk_bf16_f32 v32, v80, v81
    v_cvt_pk_bf16_f32 v33, v82, v83
    v_pk_max_i16 v32, v32, 0
    v_pk_max_i16 v33, v33, 0
    ds_write_b64 v15, v[32:33] offset:0
    v_cvt_pk_bf16_f32 v34, v84, v85
    v_cvt_pk_bf16_f32 v35, v86, v87
    v_pk_max_i16 v34, v34, 0
    v_pk_max_i16 v35, v35, 0
    ds_write_b64 v15, v[34:35] offset:1024
    v_cvt_pk_bf16_f32 v36, v88, v89
    v_cvt_pk_bf16_f32 v37, v90, v91
    v_pk_max_i16 v36, v36, 0
    v_pk_max_i16 v37, v37, 0
    ds_write_b64 v15, v[36:37] offset:2048
    v_cvt_pk_bf16_f32 v38, v92, v93
    v_cvt_pk_bf16_f32 v39, v94, v95
    v_pk_max_i16 v38, v38, 0
    v_pk_max_i16 v39, v39, 0
    ds_write_b64 v15, v[38:39] offset:3072
    v_mov_b32 v12, s36
    v_mov_b32 v13, 1
    s_mov_b32 exec_lo, 0x1
    s_mov_b32 exec_hi, 0x0
    ds_add_u32 v12, v13
    s_mov_b64 exec, -1
    v_mov_b32 v48, 0
    v_mov_b32 v49, 0
    v_mov_b32 v50, 0
    v_mov_b32 v51, 0
    v_mov_b32 v52, 0
    v_mov_b32 v53, 0
    v_mov_b32 v54, 0
    v_mov_b32 v55, 0
    v_mov_b32 v56, 0
    v_mov_b32 v57, 0
    v_mov_b32 v58, 0
    v_mov_b32 v59, 0
    v_mov_b32 v60, 0
    v_mov_b32 v61, 0
    v_mov_b32 v62, 0
    v_mov_b32 v63, 0
    v_mov_b32 v64, 0
    v_mov_b32 v65, 0
    v_mov_b32 v66, 0
    v_mov_b32 v67, 0
    v_mov_b32 v68, 0
    v_mov_b32 v69, 0
    v_mov_b32 v70, 0
    v_mov_b32 v71, 0
    v_mov_b32 v72, 0
    v_mov_b32 v73, 0
    v_mov_b32 v74, 0
    v_mov_b32 v75, 0
    v_mov_b32 v76, 0
    v_mov_b32 v77, 0
    v_mov_b32 v78, 0
    v_mov_b32 v79, 0
    v_mov_b32 v80, 0
    v_mov_b32 v81, 0
    v_mov_b32 v82, 0
    v_mov_b32 v83, 0
    v_mov_b32 v84, 0
    v_mov_b32 v85, 0
    v_mov_b32 v86, 0
    v_mov_b32 v87, 0
    v_mov_b32 v88, 0
    v_mov_b32 v89, 0
    v_mov_b32 v90, 0
    v_mov_b32 v91, 0
    v_mov_b32 v92, 0
    v_mov_b32 v93, 0
    v_mov_b32 v94, 0
    v_mov_b32 v95, 0
    s_cmp_lt_u32 s30, 4
    s_cbranch_scc0 ffn_pr1
    s_setprio 2
ffn_pr1:
    s_and_b32 s34, s30, 12
    s_cmp_eq_u32 s34, 4
    s_cbranch_scc0 ffn_pr2
    s_setprio 1
ffn_pr2:
    v_mov_b32 v12, 163472
    s_mov_b32 s3, 524288
mega_lw_h0:
    ds_read_b32 v13, v12
    s_waitcnt lgkmcnt(0)
    v_readfirstlane_b32 s39, v13
    s_nop 0
    s_cmp_ge_u32 s39, 4
    s_cbranch_scc1 mega_lwd_h0
    s_sleep 1
    s_sub_u32 s3, s3, 1
    s_cbranch_scc0 mega_lw_h0
mega_lwd_h0:
    s_branch ffn_start
ffn_hwait:
    s_cmp_eq_u32 s31, 2
    s_cbranch_scc1 ffn_nobar
    s_lshl_b32 s36, s31, 2
    s_add_u32 s36, s36, 163464
    v_mov_b32 v12, s36
    s_mov_b32 s3, 524288
mega_lw_h1:
    ds_read_b32 v13, v12
    s_waitcnt lgkmcnt(0)
    v_readfirstlane_b32 s39, v13
    s_nop 0
    s_cmp_ge_u32 s39, 4
    s_cbranch_scc1 mega_lwd_h1
    s_sleep 1
    s_sub_u32 s3, s3, 1
    s_cbranch_scc0 mega_lw_h1
mega_lwd_h1:
    s_branch ffn_nobar
mega_end:
    s_endpgm
    .set CODE_BYTES, mega_end - mega_pc

.section .rodata,"a"
.p2align 6
.amdhsa_kernel sequential_preLN__grouped_kv_mqa__dense_activation_relu__prompt_kernel
  .amdhsa_next_free_vgpr 168
  .amdhsa_next_free_sgpr 76
  .amdhsa_accum_offset 168
  .amdhsa_group_segment_fixed_size 0
  .amdhsa_kernarg_size 88
  .amdhsa_user_sgpr_count 2
  .amdhsa_user_sgpr_kernarg_segment_ptr 1
  .amdhsa_system_sgpr_workgroup_id_x 1
  .amdhsa_float_denorm_mode_32 3
.end_amdhsa_kernel
```
